```python
import torch

def _softmax(x, axis=-1):
    return torch.softmax(x, dim=axis)
def _gelu(x):
    return torch.nn.functional.gelu(x, approximate="tanh")
def _silu(x):
    return torch.nn.functional.silu(x)
def _sigmoid(x):
    return torch.sigmoid(x)
def _layernorm(x, axis=-1, eps=1e-5):
    m = x.mean(dim=axis, keepdim=True)
    v = x.var(dim=axis, keepdim=True, unbiased=False)
    return (x - m) / torch.sqrt(v + eps)
def _scatter_add(tgt, idx, src, axis=0):
    return tgt.clone().index_add_(axis, idx, src)
def _segment_sum(src, seg, n):
    out = torch.zeros((n,) + src.shape[1:], dtype=src.dtype)
    return out.index_add_(0, seg, src)
def _pad(x, pw):
    flat = tuple(v for pair in reversed(pw) for v in pair)
    return torch.nn.functional.pad(x, flat)

kernel_name = 'gated_mix__spectral_fnet__linear_kernel_hedgehog__prompt'

def setup_inputs():

    _w = (lambda a: (lambda t: t.to(torch.bfloat16) if t.is_floating_point() else t)(torch.as_tensor(a)))
    def _A_setup():
        B, S, D = 1, 2048, 576
        ns = torch.arange(S)[:, None] * torch.arange(S)[None, :]
        nd = torch.arange(D)[:, None] * torch.arange(D)[None, :]
        Ws_re = torch.cos(-2.0 * torch.pi * ns / S).to(float)
        Ws_im = torch.sin(-2.0 * torch.pi * ns / S).to(float)
        Wd_re = torch.cos(-2.0 * torch.pi * nd / D).to(float)
        Wd_im = torch.sin(-2.0 * torch.pi * nd / D).to(float)
        return {
            "x": _w((lambda *s: torch.randn(*s, dtype=torch.bfloat16) * 0.1)(B, S, D)),
            "dft_seq_re": _w(Ws_re),
            "dft_seq_im": _w(Ws_im),
            "dft_hid_re": _w(Wd_re),
            "dft_hid_im": _w(Wd_im),
        }
    _A_in = _A_setup()

    def _B_setup():
        B, S, D, H = 1, 2048, 576, 32
        Dh = D // H
        return {
            "x": _w((lambda *s: torch.randn(*s, dtype=torch.bfloat16) * 0.1)(B, S, D)),
            "wqkv": _w((lambda *s: torch.randn(*s, dtype=torch.bfloat16) * 1.6)(D, 3 * D)),
            "w_phi": _w((lambda *s: torch.randn(*s, dtype=torch.bfloat16) * 1.6)(H, Dh, Dh) * (Dh ** -0.5)),
            "wo": _w((lambda *s: torch.randn(*s, dtype=torch.bfloat16) * 1.6)(D, D)),
        }
    _B_in = _B_setup()

    return {
        "A_x": _A_in["x"],
        "A_dft_seq_re": _A_in["dft_seq_re"],
        "A_dft_seq_im": _A_in["dft_seq_im"],
        "A_dft_hid_re": _A_in["dft_hid_re"],
        "A_dft_hid_im": _A_in["dft_hid_im"],
        "B_x": _B_in["x"],
        "B_wqkv": _B_in["wqkv"],
        "B_w_phi": _B_in["w_phi"],
        "B_wo": _B_in["wo"],
        "gate_w": _w((lambda *s: torch.randn(*s, dtype=torch.bfloat16) * 0.1)(576) * 16.0),
    }

def reference(A_x, A_dft_seq_re, A_dft_seq_im, A_dft_hid_re, A_dft_hid_im, B_x, B_wqkv, B_w_phi, B_wo, gate_w):
    def _A_ref(x, dft_seq_re, dft_seq_im, dft_hid_re, dft_hid_im):
        a = torch.einsum("bsd,ed->bse", x, dft_hid_re)
        b = torch.einsum("bsd,ed->bse", x, dft_hid_im)
        y = torch.einsum("ts,bse->bte", dft_seq_re, a) - torch.einsum("ts,bse->bte", dft_seq_im, b)
        return y

    def _B_ref(x, wqkv, w_phi, wo):
        B, S, D = x.shape
        H = 32; Dh = D // H
        qkv = (lambda x, *d: x.permute(*d))((x @ wqkv).reshape(B, S, 3, H, Dh), 2, 0, 3, 1, 4)
        q, k, v = qkv[0], qkv[1], qkv[2]
        pq = torch.einsum("bhsd,hdf->bhsf", q, w_phi)
        pk = torch.einsum("bhsd,hdf->bhsf", k, w_phi)
        phi_q = torch.concatenate([_softmax(pq, axis=-1), _softmax(-pq, axis=-1)], axis=-1)
        phi_k = torch.concatenate([_softmax(pk, axis=-1), _softmax(-pk, axis=-1)], axis=-1)
        kv = torch.einsum("bhsf,bhsd->bhfd", phi_k, v)
        z  = torch.einsum("bhsf->bhf", phi_k)
        num = torch.einsum("bhqf,bhfd->bhqd", phi_q, kv)
        den = torch.einsum("bhqf,bhf->bhq", phi_q, z)[..., None] + 1e-6
        o = num / den
        return (lambda x, *d: x.permute(*d))(o, 0, 2, 1, 3).reshape(B, S, D) @ wo

    x = A_x
    g = _sigmoid((x * gate_w).sum(-1, keepdims=True))
    a = _A_ref(x, A_dft_seq_re, A_dft_seq_im, A_dft_hid_re, A_dft_hid_im)
    b = _B_ref(x, B_wqkv, B_w_phi, B_wo)
    return g * a + (1 - g) * b
```

```asm
; @launch grid=(256,1,1) block=(512,1,1) lds=163840
.amdgcn_target "amdgcn-amd-amdhsa--gfx950"
.text
.globl gated_mix__spectral_fnet__linear_kernel_hedgehog__prompt_kernel
.p2align 12
.p2align 8
.type gated_mix__spectral_fnet__linear_kernel_hedgehog__prompt_kernel,@function
gated_mix__spectral_fnet__linear_kernel_hedgehog__prompt_kernel:
    s_cmpk_ge_u32 s2, 256
    s_cbranch_scc1 L_end
    s_load_dwordx2 s[12:13], s[0:1], 48
    s_load_dwordx2 s[8:9], s[0:1], 96
    s_load_dwordx2 s[16:17], s[0:1], 56
    s_load_dwordx2 s[20:21], s[0:1], 64
    s_load_dwordx2 s[24:25], s[0:1], 72
    s_load_dwordx2 s[4:5], s[0:1], 0
    s_getpc_b64 s[38:39]
L_pc:
    v_lshrrev_b32 v1, 6, v0
    s_andn2_b32 s40, s2, 7
    v_add_lshl_u32 v2, v1, s40, 7
    v_readfirstlane_b32 s32, v1
    v_min_u32 v2, L_end-L_pc-896, v2
    global_load_dword v15, v2, s[38:39] offset:896
    v_and_b32 v0, 63, v0
    v_and_b32 v1, 15, v0
    v_lshrrev_b32 v2, 4, v0
    v_lshlrev_b32 v3, 4, v0
    s_mov_b32 s11, 0x20000
    s_bitcmp1_b32 s32, 2
    s_cbranch_scc1 L_N1
    s_and_b32 s38, s2, 7
    s_lshr_b32 s39, s2, 5
    s_lshl3_add_u32 s43, s39, s38
    s_xor_b32 s43, s43, 63
    s_bfe_u32 s45, s2, 0x20003
    s_mul_i32 s44, s43, 43
    s_lshr_b32 s44, s44, 7
    s_lshl2_add_u32 s3, s43, s45
    s_mul_i32 s47, s32, 4608
    s_add_u32 s47, s47, 96768
    s_mov_b32 m0, s47
    s_mov_b32 s42, 3
    s_cmp_ge_u32 s44, 18
    s_cbranch_scc1 L_T_wo_ld
    s_lshl2_add_u32 s45, s45, s32
    s_mul_i32 s38, s44, 3
    s_sub_u32 s38, s43, s38
    s_sub_u32 s42, s38, 1
    s_cselect_b32 s42, 2, s42
    s_mul_i32 s39, s44, 93
    s_add_u32 s39, s39, s43
    s_lshl4_add_u32 s46, s39, s45
    s_mulk_i32 s46, 72
    s_movk_i32 s38, 3376
    v_mul_u32_u24 v4, 52429, v0
    v_lshrrev_b32 v5, 18, v4
    v_mad_u32_u24 v6, v5, s38, v3
    v_add_u32 v5, 3355456, v4
    v_lshrrev_b32 v5, 18, v5
    v_mad_u32_u24 v7, v5, s38, v3
    v_add_u32 v5, 6710912, v4
    v_lshrrev_b32 v5, 18, v5
    v_mad_u32_u24 v8, v5, s38, v3
    s_mov_b32 s14, 1990656
    s_mov_b32 s15, s11
    s_movk_i32 s18, 20736
    s_mov_b32 s19, s11
    v_mul_u32_u24 v4, 21846, v0
    v_lshrrev_b32 v5, 16, v4
    v_mad_i32_i24 v9, v5, -12, v3
    v_add_u32 v5, 1398144, v4
    v_lshrrev_b32 v5, 16, v5
    v_mad_i32_i24 v10, v5, -12, v3
    v_cmp_gt_u32 vcc, 44, v0
    v_add_u32 v10, 1024, v10
    s_mul_i32 s48, s45, 1296
    v_cndmask_b32 v10, -16, v10, vcc
    s_waitcnt lgkmcnt(0)
    buffer_load_dwordx4 v6, s[12:15], s46 offen lds
    buffer_load_dwordx4 v7, s[12:15], s46 offen offset:1024 lds
    s_mov_b32 exec_hi, 0
    buffer_load_dwordx4 v8, s[12:15], s46 offen offset:2048 lds
    s_mov_b64 exec, -1
    s_cmp_eq_u32 s42, 1
    s_cbranch_scc1 L_T_v_ld
    s_add_u32 m0, s47, 2560
    s_nop 0
    buffer_load_dwordx4 v9, s[16:19], s48 offen lds
    s_add_u32 m0, s47, 3584
    s_nop 0
    buffer_load_dwordx4 v10, s[16:19], s48 offen lds
    s_branch L_T1
L_T_v_ld:
    v_lshlrev_b32 v5, 4, v2
    s_movk_i32 s26, 1152
    s_mov_b32 s27, s11
    s_lshl_b32 s38, s44, 6
    buffer_load_dwordx4 v[72:75], v5, s[24:27], s38 offen
    s_branch L_T1
L_T_wo_ld:
    s_sub_u32 s43, s3, 216
    s_cmp_ge_u32 s43, 36
    s_cselect_b32 s38, 4, 0
    s_sub_u32 s43, s43, s38
    s_lshr_b32 s44, s43, 1
    s_and_b32 s45, s43, 1
    s_lshl2_add_u32 s45, s45, s32
    s_mul_i32 s46, s44, 41472
    s_mul_i32 s38, s44, 331776
    s_sub_u32 s38, s38, 5289984
    s_cmp_lt_u32 s44, 16
    s_cselect_b32 s46, s46, s38
    s_cselect_b32 s48, 4, 2
    s_cselect_b32 s49, 4, 32
    s_cselect_b32 s50, 0, 32
    s_cselect_b32 s51, 1, 9
    s_cselect_b32 s52, 3, 18
    s_mulk_i32 s51, 9216
    s_mulk_i32 s52, 4608
    v_lshrrev_b32 v4, 3, v0
    v_lshrrev_b32 v5, 5, v0
    v_mad_u32_u24 v5, v5, s50, v4
    v_mul_u32_u24 v5, 1152, v5
    v_and_b32 v6, 0x70, v3
    s_lshr_b32 s38, s45, 2
    s_add_u32 s38, s38, s45
    s_lshl_b32 s38, s38, 7
    v_add3_u32 v6, v6, v5, s38
    v_lshrrev_b32 v5, s48, v0
    v_mad_u32_u24 v5, v5, s49, v0
    v_mul_u32_u24 v5, 1152, v5
    s_lshl4_add_u32 s39, s45, s46
    s_mov_b32 s22, 663552
    s_mov_b32 s23, s11
    s_waitcnt lgkmcnt(0)
    buffer_load_dwordx4 v6, s[20:23], s46 offen lds
    s_addk_i32 m0, 1024
    s_add_u32 s46, s46, s51
    buffer_load_dwordx4 v6, s[20:23], s46 offen lds
    s_addk_i32 m0, 1024
    s_add_u32 s46, s46, s52
    buffer_load_dwordx4 v6, s[20:23], s46 offen lds
    s_addk_i32 m0, 1024
    s_add_u32 s46, s46, s51
    buffer_load_dwordx4 v6, s[20:23], s46 offen lds
    s_addk_i32 m0, 512
    s_mov_b32 exec_hi, 0
    buffer_load_dwordx4 v5, s[20:23], s39 offen offset:512 lds
    s_mov_b64 exec, -1
L_T1:
    s_and_b32 s38, s2, 3
    s_bfe_u32 s39, s2, 0x20003
    s_lshl2_add_u32 s33, s38, s39
    s_bfe_u32 s38, s2, 0x10002
    s_lshr_b32 s39, s2, 5
    s_lshl3_add_u32 s34, s38, s39
    s_lshl1_add_u32 s35, s33, s34
    s_mul_i32 s38, s35, 57
    s_lshr_b32 s38, s38, 9
    s_mul_i32 s38, s38, 9
    s_sub_u32 s35, s35, s38
    s_lshl4_add_u32 s37, s33, s34
    s_mov_b32 s10, 8757248
    s_mov_b32 s58, 1048576
    s_lshr_b32 s38, s33, 1
    s_add_u32 s40, s38, 1
    s_and_b32 s40, s40, 7
    s_sub_u32 s38, 15, s38
    s_bitcmp1_b32 s33, 0
    s_cselect_b32 s40, s38, s40
    v_and_b32 v104, 7, v0
    v_xor_b32 v104, v104, v2
    v_lshrrev_b32 v105, 3, v0
    v_mul_u32_u24 v105, 73728, v105
    v_lshl_add_u32 v104, v104, 4, v105
    v_xor_b32 v105, 64, v104
    v_add_u32 v105, 589824, v105
    s_lshl4_add_u32 s92, s32, s40
    s_mul_i32 s92, s92, 1152
    s_lshl_b32 s93, s35, 7
    s_lshl_b32 s94, s32, 12
    s_mov_b32 s6, 2359296
    s_mov_b32 s7, s11
    s_add_u32 s38, s92, s93
    s_add_u32 s39, s38, 1179648
    s_add_u32 m0, s94, 80384
    s_nop 0
    buffer_load_dwordx4 v104, s[4:7], s38 offen lds
    s_add_u32 m0, s94, 81408
    s_add_u32 s93, s93, 128
    buffer_load_dwordx4 v105, s[4:7], s38 offen lds
    s_add_u32 m0, s94, 82432
    s_cmpk_eq_u32 s93, 1152
    s_cselect_b32 s93, 0, s93
    buffer_load_dwordx4 v104, s[4:7], s39 offen lds
    s_add_u32 m0, s94, 83456
    s_nop 0
    buffer_load_dwordx4 v105, s[4:7], s39 offen lds
    s_load_dword s36, s[8:9], 0
    s_lshl1_add_u32 s38, s32, 1
    v_bfe_u32 v5, v0, 2, 1
    v_add_u32 v5, s38, v5
    v_bfe_u32 v7, v0, 3, 1
    v_lshlrev_b32 v7, 4, v7
    v_bfe_u32 v4, v0, 1, 1
    v_cmp_eq_u32 vcc, 8, v5
    v_add_u32 v5, v5, v7
    v_sub_u32 v6, 0, v4
    v_xor_b32 v5, v5, v6
    v_add_u32 v5, v5, v4
    v_lshl_add_u32 v7, v4, 3, v7
    v_cndmask_b32 v4, v5, v7, vcc
    v_and_b32 v4, 31, v4
    v_cvt_f32_u32 v114, v4
    v_mul_f32 v114, 0x3d000000, v114
    v_and_b32 v5, 1, v0
    v_lshlrev_b32 v5, 1, v5
    v_mad_u32_u24 v5, v4, v2, v5
    v_and_b32 v5, 7, v5
    v_cvt_f32_u32 v120, v5
    v_mul_f32 v120, 0x3e000000, v120
    v_add_f32 v121, v120, v114
    v_add_f32 v122, v121, v114
    v_add_f32 v123, v122, v114
    v_bfe_i32 v4, v4, 0, 1
    v_and_b32 v4, 0x80008000, v4
    s_lshl_b32 s38, s32, 11
    s_add_u32 s38, s38, 23040
    v_add_u32 v115, s38, v3
    v_cos_f32 v128, v120
    v_sin_f32 v120, v120
    v_cos_f32 v129, v121
    v_sin_f32 v121, v121
    v_cos_f32 v130, v122
    v_sin_f32 v122, v122
    v_cos_f32 v131, v123
    v_sin_f32 v123, v123
    v_cvt_pk_bf16_f32 v136, v128, v129
    v_cvt_pk_bf16_f32 v140, v120, v121
    v_cvt_pk_bf16_f32 v137, v130, v131
    v_cvt_pk_bf16_f32 v141, v122, v123
    v_xor_b32 v138, v4, v136
    v_xor_b32 v142, v4, v140
    v_xor_b32 v139, v4, v137
    v_xor_b32 v143, v4, v141
    ds_write_b128 v115, v[136:139]
    ds_write_b128 v115, v[140:143] offset:1024
    s_lshl_b32 s38, s32, 8
    s_add_u32 s38, s38, 161792
    v_lshl_add_u32 v115, v0, 2, s38
    v_mov_b32 v116, 0
    ds_write_b32 v115, v116
    v_lshrrev_b32 v4, 1, v1
    v_xor_b32 v4, v4, v2
    v_lshlrev_b32 v4, 4, v4
    v_lshl_add_u32 v4, v1, 7, v4
    s_lshl_b32 s38, s32, 12
    s_add_u32 s38, s38, 31232
    v_add_u32 v4, s38, v4
    v_xor_b32 v5, 64, v4
    v_lshrrev_b32 v7, 1, v2
    v_and_b32 v6, 1, v2
    v_cmp_eq_u32 s[56:57], 1, v6
    v_mul_u32_u24 v6, 18432, v6
    v_lshl_add_u32 v6, v1, 3, v6
    v_lshl_add_u32 v6, v7, 2, v6
    s_lshl2_add_u32 s38, s33, s32
    s_mul_i32 s38, s38, 36864
    s_add_u32 s38, s38, 6397952
    s_lshl_b32 s39, s34, 10
    s_add_u32 s46, s38, s39
    s_add_u32 s88, s46, 18432
    s_lshl_b32 s39, s34, 7
    s_add_u32 s89, s38, s39
    s_add_u32 s89, s89, 16384
    s_cmp_ge_u32 s3, 216
    s_cselect_b32 s38, 16, 0
    s_add_u32 s38, s38, s45
    s_cmp_ge_u32 s3, 252
    s_cselect_b32 s38, 24, s38
    s_lshl_b32 s90, s38, 7
    s_add_u32 s90, s90, 65536
    s_mov_b32 s40, 1069066811
    s_mov_b32 s41, 3216550459
    s_and_b32 s39, s34, 7
    s_add_u32 s39, s39, 16
    s_cmp_eq_u32 s32, 0
    s_cselect_b32 s39, s34, s39
    s_cselect_b32 s55, 54, 18
    s_lshl_b32 s91, s39, 7
    s_add_u32 s91, s91, 65536
    s_mul_i32 s30, s34, 55296
    s_add_u32 s30, s30, 393216
    s_mul_i32 s28, s35, 6144
    s_mov_b32 s29, 96768
    v_and_b32 v8, 3, v1
    v_add_u32 v7, v8, v2
    v_and_b32 v7, 3, v7
    v_lshlrev_b32 v7, 6, v7
    v_lshl_add_u32 v7, v8, 8, v7
    v_lshrrev_b32 v8, 2, v1
    v_lshl_add_u32 v7, v8, 4, v7
    v_add_u32 v7, 98816, v7
    s_lshl_b32 s38, s32, 5
    v_add_u32 v10, s38, v1
    v_mul_u32_u24 v8, 144, v10
    v_lshl_add_u32 v9, v2, 2, v8
    v_add_u32 v9, 123520, v9
    v_lshl_add_u32 v8, v2, 5, v8
    v_add_u32 v8, 123392, v8
    v_lshlrev_b32 v11, 2, v10
    v_mul_u32_u24 v10, 80, v10
    v_lshl_add_u32 v10, v2, 2, v10
    v_add_u32 v10, 141888, v10
    v_bfe_u32 v144, v0, 2, 2
    v_lshl_add_u32 v144, v2, 3, v144
    v_and_b32 v145, 3, v0
    s_cmp_eq_u32 s42, 3
    s_cbranch_scc1 L_T_wo
    s_mul_i32 s48, s45, 55296
    s_mul_i32 s38, s44, 3072
    s_add_u32 s48, s48, s38
    s_add_u32 s48, s48, 393216
    s_mul_i32 s49, s45, 36864
    s_lshl_b32 s38, s44, 11
    s_add_u32 s49, s49, s38
    v_add_u32 v146, s42, v2
    v_and_b32 v146, 3, v146
    v_lshlrev_b32 v146, 6, v146
    s_lshl_b32 s38, s42, 8
    s_add_u32 s50, s48, s38
    s_cmp_eq_u32 s42, 1
    s_cbranch_scc1 L_T_v
    s_add_u32 s49, s49, 1867776
    s_cmp_eq_u32 s42, 0
    s_cselect_b32 s49, s48, s49
    s_add_u32 s38, s47, 2560
    v_lshl_add_u32 v147, v145, 3, s38
    s_add_u32 s38, s38, 32
    v_mov_b32 v148, s38
    v_add_u32 v149, 0, v144
    v_cmp_gt_u32 vcc, 18, v149
    s_nop 1
    v_cndmask_b32 v149, 36, v149, vcc
    v_cmp_eq_u32 vcc, 0, v145
    v_mad_u32_u24 v16, v149, 48, v147
    s_nop 0
    v_cndmask_b32 v149, 36, v149, vcc
    v_mad_u32_u24 v17, v149, 48, v148
    v_add_u32 v149, 4, v144
    v_cmp_le_u32 vcc, 18, v149
    s_nop 1
    v_cndmask_b32 v149, 36, v149, vcc
    v_cmp_eq_u32 vcc, 1, v145
    v_mad_u32_u24 v18, v149, 48, v147
    s_nop 0
    v_cndmask_b32 v149, 36, v149, vcc
    v_mad_u32_u24 v19, v149, 48, v148
    v_add_u32 v149, 4, v144
    v_cmp_gt_u32 vcc, 18, v149
    s_nop 1
    v_cndmask_b32 v149, 36, v149, vcc
    v_cmp_eq_u32 vcc, 0, v145
    v_mad_u32_u24 v20, v149, 48, v147
    s_nop 0
    v_cndmask_b32 v149, 36, v149, vcc
    v_mad_u32_u24 v21, v149, 48, v148
    v_add_u32 v149, 8, v144
    v_cmp_le_u32 vcc, 18, v149
    s_nop 1
    v_cndmask_b32 v149, 36, v149, vcc
    v_cmp_eq_u32 vcc, 1, v145
    v_mad_u32_u24 v22, v149, 48, v147
    s_nop 0
    v_cndmask_b32 v149, 36, v149, vcc
    v_mad_u32_u24 v23, v149, 48, v148
    v_lshrrev_b32 v149, 2, v1
    v_lshl_add_u32 v149, v149, 2, v1
    s_movk_i32 s38, 80
    v_lshl_add_u32 v150, v2, 4, s47
    v_mad_u32_u24 v149, v149, s38, v150
    v_lshrrev_b32 v150, 3, v1
    v_mul_u32_u24 v150, 896, v150
    v_add_u32 v150, v150, v3
    v_lshrrev_b32 v151, 1, v1
    v_and_or_b32 v151, v1, 1, v151
    v_lshl_add_u32 v151, v151, 4, v146
    s_waitcnt vmcnt(4)
    ds_read_b64_tr_b16 v[24:25], v16
    ds_read_b64_tr_b16 v[26:27], v20
    ds_read_b64_tr_b16 v[28:29], v17
    ds_read_b64_tr_b16 v[30:31], v21
    ds_read_b128 v[40:43], v149 offset:0
    ds_read_b128 v[44:47], v149 offset:320
    ds_read_b64_tr_b16 v[32:33], v18
    ds_read_b64_tr_b16 v[34:35], v22
    ds_read_b64_tr_b16 v[36:37], v19
    ds_read_b64_tr_b16 v[38:39], v23
    ds_read_b128 v[48:51], v149 offset:8
    ds_read_b128 v[52:55], v149 offset:328
    s_waitcnt lgkmcnt(6)
    v_mfma_f32_16x16x32_bf16 v[56:59], v[40:43], v[24:27], 0
    v_mfma_f32_16x16x32_bf16 v[60:63], v[44:47], v[24:27], 0
    v_mfma_f32_16x16x32_bf16 v[72:75], v[40:43], v[28:31], 0
    v_mfma_f32_16x16x32_bf16 v[76:79], v[44:47], v[28:31], 0
    s_waitcnt lgkmcnt(0)
    v_mfma_f32_16x16x32_bf16 v[64:67], v[48:51], v[32:35], 0
    v_mfma_f32_16x16x32_bf16 v[68:71], v[52:55], v[32:35], 0
    v_mfma_f32_16x16x32_bf16 v[72:75], v[48:51], v[36:39], v[72:75]
    v_mfma_f32_16x16x32_bf16 v[76:79], v[52:55], v[36:39], v[76:79]
    v_cvt_pk_bf16_f32 v80, v56, v57
    v_cvt_pk_bf16_f32 v81, v58, v59
    v_cvt_pk_bf16_f32 v82, v60, v61
    v_cvt_pk_bf16_f32 v83, v62, v63
    s_add_u32 s38, s92, s93
    s_add_u32 s39, s38, 1179648
    s_add_u32 m0, s94, 31232
    s_nop 0
    buffer_load_dwordx4 v104, s[4:7], s38 offen lds
    s_add_u32 m0, s94, 32256
    s_add_u32 s93, s93, 128
    buffer_load_dwordx4 v105, s[4:7], s38 offen lds
    s_add_u32 m0, s94, 33280
    s_cmpk_eq_u32 s93, 1152
    s_cselect_b32 s93, 0, s93
    buffer_load_dwordx4 v104, s[4:7], s39 offen lds
    s_add_u32 m0, s94, 34304
    s_nop 0
    buffer_load_dwordx4 v105, s[4:7], s39 offen lds
    s_add_u32 s38, s92, s93
    s_add_u32 s39, s38, 1179648
    s_add_u32 m0, s94, 47616
    s_nop 0
    buffer_load_dwordx4 v104, s[4:7], s38 offen lds
    s_add_u32 m0, s94, 48640
    s_add_u32 s93, s93, 128
    buffer_load_dwordx4 v105, s[4:7], s38 offen lds
    s_add_u32 m0, s94, 49664
    s_cmpk_eq_u32 s93, 1152
    s_cselect_b32 s93, 0, s93
    buffer_load_dwordx4 v104, s[4:7], s39 offen lds
    s_add_u32 m0, s94, 50688
    s_nop 0
    buffer_load_dwordx4 v105, s[4:7], s39 offen lds
    buffer_store_dwordx4 v[80:83], v150, s[8:11], s49 offen offset:0 sc1
    v_cvt_pk_bf16_f32 v84, v64, v65
    v_cvt_pk_bf16_f32 v85, v66, v67
    v_cvt_pk_bf16_f32 v86, v68, v69
    v_cvt_pk_bf16_f32 v87, v70, v71
    buffer_store_dwordx4 v[84:87], v150, s[8:11], s49 offen offset:128 sc1
    v_cvt_pk_bf16_f32 v88, v72, v73
    v_cvt_pk_bf16_f32 v89, v74, v75
    v_cvt_pk_bf16_f32 v90, v76, v77
    v_cvt_pk_bf16_f32 v91, v78, v79
    s_mov_b32 exec_lo, 0x330033
    s_mov_b32 exec_hi, 0x330033
    buffer_store_dwordx4 v[88:91], v151, s[8:11], s50 offen offset:2048 sc1
    s_branch L_T_A
L_T_v:
    s_add_u32 s49, s49, 1277952
    s_movk_i32 s38, 80
    v_mov_b32 v148, s47
    v_mad_u32_u24 v148, v144, s38, v148
    v_lshrrev_b32 v149, 1, v145
    v_lshl_add_u32 v149, v149, 3, v148
    v_lshl_add_u32 v149, v145, 4, v149
    v_lshl_add_u32 v151, v1, 4, v146
    v_xor_b32 v150, 128, v151
    s_waitcnt vmcnt(4)
    ds_read_b64_tr_b16 v[80:81], v149 offset:0
    ds_read_b64_tr_b16 v[82:83], v149 offset:320
    ds_read_b64_tr_b16 v[84:85], v149 offset:8
    ds_read_b64_tr_b16 v[86:87], v149 offset:328
    ds_read_b64_tr_b16 v[88:89], v148 offset:32
    ds_read_b64_tr_b16 v[90:91], v148 offset:352
    s_add_u32 s38, s92, s93
    s_add_u32 s39, s38, 1179648
    s_add_u32 m0, s94, 31232
    s_nop 0
    buffer_load_dwordx4 v104, s[4:7], s38 offen lds
    s_add_u32 m0, s94, 32256
    s_add_u32 s93, s93, 128
    buffer_load_dwordx4 v105, s[4:7], s38 offen lds
    s_add_u32 m0, s94, 33280
    s_cmpk_eq_u32 s93, 1152
    s_cselect_b32 s93, 0, s93
    buffer_load_dwordx4 v104, s[4:7], s39 offen lds
    s_add_u32 m0, s94, 34304
    s_nop 0
    buffer_load_dwordx4 v105, s[4:7], s39 offen lds
    s_add_u32 s38, s92, s93
    s_add_u32 s39, s38, 1179648
    s_add_u32 m0, s94, 47616
    s_nop 0
    buffer_load_dwordx4 v104, s[4:7], s38 offen lds
    s_add_u32 m0, s94, 48640
    s_add_u32 s93, s93, 128
    buffer_load_dwordx4 v105, s[4:7], s38 offen lds
    s_add_u32 m0, s94, 49664
    s_cmpk_eq_u32 s93, 1152
    s_cselect_b32 s93, 0, s93
    buffer_load_dwordx4 v104, s[4:7], s39 offen lds
    s_add_u32 m0, s94, 50688
    s_nop 0
    buffer_load_dwordx4 v105, s[4:7], s39 offen lds
    s_waitcnt lgkmcnt(4)
    buffer_store_dwordx4 v[80:83], v3, s[8:11], s49 offen offset:0 sc1
    s_waitcnt lgkmcnt(2)
    buffer_store_dwordx4 v[84:87], v3, s[8:11], s49 offen offset:1024 sc1
    s_waitcnt lgkmcnt(0)
    s_mov_b32 exec_lo, 0xf000f
    s_mov_b32 exec_hi, 0xf000f
    buffer_store_dwordx4 v[88:91], v151, s[8:11], s50 offen offset:2048 sc1
    buffer_store_dwordx4 v[72:75], v150, s[8:11], s50 offen offset:2560 sc1
    s_branch L_T_A
L_T_wo:
    s_mul_i32 s49, s45, 82944
    s_mul_i32 s38, s44, 4608
    s_add_u32 s49, s49, s38
    s_add_u32 s49, s49, 2457600
    s_add_u32 s50, s49, 4096
    v_lshl_add_u32 v147, v145, 3, s47
    v_lshl_add_u32 v148, v144, 7, v147
    v_lshl_add_u32 v147, v144, 4, v147
    v_xor_b32 v149, 16, v3
    v_xor_b32 v150, 32, v3
    v_xor_b32 v151, 48, v3
    v_lshlrev_b32 v152, 4, v1
    v_lshl_add_u32 v152, v2, 7, v152
    s_waitcnt vmcnt(4)
    ds_read_b64_tr_b16 v[80:81], v148 offset:0
    ds_read_b64_tr_b16 v[82:83], v148 offset:512
    ds_read_b64_tr_b16 v[84:85], v148 offset:32
    ds_read_b64_tr_b16 v[86:87], v148 offset:544
    ds_read_b64_tr_b16 v[88:89], v148 offset:64
    ds_read_b64_tr_b16 v[90:91], v148 offset:576
    ds_read_b64_tr_b16 v[92:93], v148 offset:96
    ds_read_b64_tr_b16 v[94:95], v148 offset:608
    ds_read_b64_tr_b16 v[96:97], v147 offset:4096
    ds_read_b64_tr_b16 v[98:99], v147 offset:4160
    s_add_u32 s38, s92, s93
    s_add_u32 s39, s38, 1179648
    s_add_u32 m0, s94, 31232
    s_nop 0
    buffer_load_dwordx4 v104, s[4:7], s38 offen lds
    s_add_u32 m0, s94, 32256
    s_add_u32 s93, s93, 128
    buffer_load_dwordx4 v105, s[4:7], s38 offen lds
    s_add_u32 m0, s94, 33280
    s_cmpk_eq_u32 s93, 1152
    s_cselect_b32 s93, 0, s93
    buffer_load_dwordx4 v104, s[4:7], s39 offen lds
    s_add_u32 m0, s94, 34304
    s_nop 0
    buffer_load_dwordx4 v105, s[4:7], s39 offen lds
    s_add_u32 s38, s92, s93
    s_add_u32 s39, s38, 1179648
    s_add_u32 m0, s94, 47616
    s_nop 0
    buffer_load_dwordx4 v104, s[4:7], s38 offen lds
    s_add_u32 m0, s94, 48640
    s_add_u32 s93, s93, 128
    buffer_load_dwordx4 v105, s[4:7], s38 offen lds
    s_add_u32 m0, s94, 49664
    s_cmpk_eq_u32 s93, 1152
    s_cselect_b32 s93, 0, s93
    buffer_load_dwordx4 v104, s[4:7], s39 offen lds
    s_add_u32 m0, s94, 50688
    s_nop 0
    buffer_load_dwordx4 v105, s[4:7], s39 offen lds
    s_waitcnt lgkmcnt(8)
    buffer_store_dwordx4 v[80:83], v3, s[8:11], s49 offen offset:0 sc1
    s_waitcnt lgkmcnt(6)
    buffer_store_dwordx4 v[84:87], v149, s[8:11], s49 offen offset:1024 sc1
    s_waitcnt lgkmcnt(4)
    buffer_store_dwordx4 v[88:91], v150, s[8:11], s49 offen offset:2048 sc1
    s_waitcnt lgkmcnt(2)
    buffer_store_dwordx4 v[92:95], v151, s[8:11], s49 offen offset:3072 sc1
    s_waitcnt lgkmcnt(0)
    s_mov_b32 exec_lo, 0xff00ff
    s_mov_b32 exec_hi, 0xff00ff
    buffer_store_dwordx4 v[96:99], v152, s[8:11], s50 offen sc1
L_T_A:
    s_mov_b64 exec, -1
    s_waitcnt lgkmcnt(0)
    s_add_u32 s36, s36, 0x9e3779b9
    s_and_b32 s3, s36, 0xffffff80
    s_waitcnt vmcnt(13)
    s_cmp_eq_u32 s42, 3
    s_cbranch_scc1 L_T_ww0
    s_waitcnt vmcnt(12)
    s_cmp_eq_u32 s42, 1
    s_cbranch_scc1 L_T_ww0
    s_waitcnt vmcnt(11)
L_T_ww0:
    s_barrier
    ds_read_b128 v[112:115], v4 offset:49152
    ds_read_b128 v[116:119], v4 offset:51200
    ds_read_b128 v[120:123], v5 offset:49152
    ds_read_b128 v[124:127], v5 offset:51200
    s_add_u32 s38, s92, s93
    s_add_u32 s39, s38, 1179648
    s_add_u32 m0, s94, 64000
    s_nop 0
    buffer_load_dwordx4 v104, s[4:7], s38 offen lds
    s_add_u32 m0, s94, 65024
    s_add_u32 s93, s93, 128
    buffer_load_dwordx4 v105, s[4:7], s38 offen lds
    s_add_u32 m0, s94, 66048
    s_cmpk_eq_u32 s93, 1152
    s_cselect_b32 s93, 0, s93
    buffer_load_dwordx4 v104, s[4:7], s39 offen lds
    s_add_u32 m0, s94, 67072
    s_nop 0
    buffer_load_dwordx4 v105, s[4:7], s39 offen lds
    s_waitcnt lgkmcnt(0)
    s_waitcnt vmcnt(13)
    s_cmp_eq_u32 s42, 3
    s_cbranch_scc1 L_T_ww1
    s_waitcnt vmcnt(12)
    s_cmp_eq_u32 s42, 1
    s_cbranch_scc1 L_T_ww1
    s_waitcnt vmcnt(11)
L_T_ww1:
    s_barrier
    ds_read_b128 v[128:131], v4 offset:0
    ds_read_b128 v[132:135], v4 offset:2048
    ds_read_b128 v[136:139], v5 offset:0
    ds_read_b128 v[140:143], v5 offset:2048
    s_add_u32 s38, s92, s93
    s_add_u32 s39, s38, 1179648
    s_add_u32 m0, s94, 80384
    s_nop 0
    buffer_load_dwordx4 v104, s[4:7], s38 offen lds
    s_add_u32 m0, s94, 81408
    s_add_u32 s93, s93, 128
    buffer_load_dwordx4 v105, s[4:7], s38 offen lds
    s_add_u32 m0, s94, 82432
    s_cmpk_eq_u32 s93, 1152
    s_cselect_b32 s93, 0, s93
    buffer_load_dwordx4 v104, s[4:7], s39 offen lds
    s_add_u32 m0, s94, 83456
    s_nop 0
    buffer_load_dwordx4 v105, s[4:7], s39 offen lds
    s_waitcnt lgkmcnt(0)
    s_waitcnt vmcnt(8)
    s_mov_b32 s52, 1
    s_atomic_add s52, s[8:9], s90 glc
    s_barrier
    ds_read_b128 v[144:147], v4 offset:16384
    ds_read_b128 v[148:151], v4 offset:18432
    ds_read_b128 v[152:155], v5 offset:16384
    ds_read_b128 v[156:159], v5 offset:18432
    ds_read_b32 v13, v4
    s_add_u32 s38, s92, s93
    s_add_u32 s39, s38, 1179648
    s_add_u32 m0, s94, 31232
    s_nop 0
    buffer_load_dwordx4 v104, s[4:7], s38 offen lds
    s_add_u32 m0, s94, 32256
    s_add_u32 s93, s93, 128
    buffer_load_dwordx4 v105, s[4:7], s38 offen lds
    s_add_u32 m0, s94, 33280
    s_cmpk_eq_u32 s93, 1152
    s_cselect_b32 s93, 0, s93
    buffer_load_dwordx4 v104, s[4:7], s39 offen lds
    s_add_u32 m0, s94, 34304
    s_nop 0
    buffer_load_dwordx4 v105, s[4:7], s39 offen lds
    s_waitcnt lgkmcnt(1)
    s_waitcnt vmcnt(8)
    s_barrier
    ds_read_b128 v[160:163], v4 offset:32768
    ds_read_b128 v[164:167], v4 offset:34816
    ds_read_b128 v[168:171], v5 offset:32768
    ds_read_b128 v[172:175], v5 offset:34816
    s_add_u32 s38, s92, s93
    s_add_u32 s39, s38, 1179648
    s_add_u32 m0, s94, 47616
    s_nop 0
    buffer_load_dwordx4 v104, s[4:7], s38 offen lds
    s_add_u32 m0, s94, 48640
    s_add_u32 s93, s93, 128
    buffer_load_dwordx4 v105, s[4:7], s38 offen lds
    s_add_u32 m0, s94, 49664
    s_cmpk_eq_u32 s93, 1152
    s_cselect_b32 s93, 0, s93
    buffer_load_dwordx4 v104, s[4:7], s39 offen lds
    s_add_u32 m0, s94, 50688
    s_nop 0
    buffer_load_dwordx4 v105, s[4:7], s39 offen lds
    s_waitcnt lgkmcnt(0)
    s_sub_u32 s52, s52, s3
    s_cmp_lt_u32 s52, 0x80
    s_cbranch_scc0 L_rep1
L_ok1:
    s_waitcnt vmcnt(8)
    s_barrier
    ds_read_b128 v[176:179], v4 offset:49152
    ds_read_b128 v[180:183], v4 offset:51200
    ds_read_b128 v[184:187], v5 offset:49152
    ds_read_b128 v[188:191], v5 offset:51200
    ds_read_b32 v13, v4
    s_add_u32 s38, s92, s93
    s_add_u32 s39, s38, 1179648
    s_add_u32 m0, s94, 64000
    s_nop 0
    buffer_load_dwordx4 v104, s[4:7], s38 offen lds
    s_add_u32 m0, s94, 65024
    s_add_u32 s93, s93, 128
    buffer_load_dwordx4 v105, s[4:7], s38 offen lds
    s_add_u32 m0, s94, 66048
    s_cmpk_eq_u32 s93, 1152
    s_cselect_b32 s93, 0, s93
    buffer_load_dwordx4 v104, s[4:7], s39 offen lds
    s_add_u32 m0, s94, 67072
    s_nop 0
    buffer_load_dwordx4 v105, s[4:7], s39 offen lds
    s_add_u32 s52, s3, s55
    s_cmp_ge_u32 s32, 2
    s_cbranch_scc1 L_T_nl
    s_mov_b32 s52, 0
    s_atomic_add s52, s[8:9], s91 glc
L_T_nl:
    s_waitcnt lgkmcnt(1)
    s_waitcnt vmcnt(8)
    s_barrier
    ds_read_b128 v[192:195], v4 offset:0
    ds_read_b128 v[196:199], v4 offset:2048
    ds_read_b128 v[200:203], v5 offset:0
    ds_read_b128 v[204:207], v5 offset:2048
    s_add_u32 s38, s92, s93
    s_add_u32 s39, s38, 1179648
    s_add_u32 m0, s94, 80384
    s_nop 0
    buffer_load_dwordx4 v104, s[4:7], s38 offen lds
    s_add_u32 m0, s94, 81408
    s_add_u32 s93, s93, 128
    buffer_load_dwordx4 v105, s[4:7], s38 offen lds
    s_add_u32 m0, s94, 82432
    s_cmpk_eq_u32 s93, 1152
    s_cselect_b32 s93, 0, s93
    buffer_load_dwordx4 v104, s[4:7], s39 offen lds
    s_add_u32 m0, s94, 83456
    s_nop 0
    buffer_load_dwordx4 v105, s[4:7], s39 offen lds
    s_waitcnt vmcnt(8)
    s_barrier
    ds_read_b128 v[208:211], v4 offset:16384
    ds_read_b128 v[212:215], v4 offset:18432
    ds_read_b128 v[216:219], v5 offset:16384
    ds_read_b128 v[220:223], v5 offset:18432
    s_cmp_eq_u32 s32, 0
    s_cbranch_scc1 L_T_w0
L_T_rest:
    s_waitcnt vmcnt(4)
    s_barrier
    ds_read_b128 v[224:227], v4 offset:32768
    ds_read_b128 v[228:231], v4 offset:34816
    ds_read_b128 v[232:235], v5 offset:32768
    ds_read_b128 v[236:239], v5 offset:34816
    s_waitcnt vmcnt(0)
    s_barrier
    ds_read_b128 v[240:243], v4 offset:49152
    ds_read_b128 v[244:247], v4 offset:51200
    ds_read_b128 v[248:251], v5 offset:49152
    ds_read_b128 v[252:255], v5 offset:51200
    s_waitcnt lgkmcnt(0)
    s_sub_u32 s52, s52, s3
    s_cmp_eq_u32 s52, s55
    s_cbranch_scc0 L_rep2
L_ok2:
    s_cmp_lg_u32 s32, 0
    s_cbranch_scc1 L_T_k
    s_mov_b32 s54, 11
    s_call_b64 s[44:45], L_kdma
L_T_k:
    v_add_u32 v4, 96768, v3
    s_waitcnt lgkmcnt(0)
    s_waitcnt vmcnt(12)
    s_barrier
    ds_read_b128 v[40:43], v4 offset:0
    ds_read_b128 v[44:47], v4 offset:1024
    ds_read_b128 v[48:51], v7 offset:0
    ds_read_b128 v[52:55], v4 offset:3072
    ds_read_b128 v[56:59], v4 offset:4096
    ds_read_b128 v[60:63], v7 offset:3072
    s_waitcnt lgkmcnt(3)
    v_mfma_f32_16x16x32_bf16 v[16:19], v[40:43], v[112:115], 0
    ds_read_b128 v[64:67], v4 offset:6144
    v_mfma_f32_16x16x32_bf16 v[20:23], v[40:43], v[116:119], 0
    v_mfma_f32_16x16x32_bf16 v[24:27], v[44:47], v[112:115], 0
    ds_read_b128 v[68:71], v4 offset:7168
    v_mfma_f32_16x16x32_bf16 v[28:31], v[44:47], v[116:119], 0
    v_mfma_f32_16x16x32_bf16 v[32:35], v[48:51], v[112:115], 0
    ds_read_b128 v[72:75], v7 offset:6144
    v_mfma_f32_16x16x32_bf16 v[36:39], v[48:51], v[116:119], 0
    s_waitcnt lgkmcnt(3)
    v_mfma_f32_16x16x32_bf16 v[16:19], v[52:55], v[120:123], v[16:19]
    ds_read_b128 v[40:43], v4 offset:9216
    v_mfma_f32_16x16x32_bf16 v[20:23], v[52:55], v[124:127], v[20:23]
    v_mfma_f32_16x16x32_bf16 v[24:27], v[56:59], v[120:123], v[24:27]
    ds_read_b128 v[44:47], v4 offset:10240
    v_mfma_f32_16x16x32_bf16 v[28:31], v[56:59], v[124:127], v[28:31]
    v_mfma_f32_16x16x32_bf16 v[32:35], v[60:63], v[120:123], v[32:35]
    ds_read_b128 v[48:51], v7 offset:9216
    v_mfma_f32_16x16x32_bf16 v[36:39], v[60:63], v[124:127], v[36:39]
    s_waitcnt lgkmcnt(3)
    v_mfma_f32_16x16x32_bf16 v[16:19], v[64:67], v[128:131], v[16:19]
    ds_read_b128 v[52:55], v4 offset:12288
    v_mfma_f32_16x16x32_bf16 v[20:23], v[64:67], v[132:135], v[20:23]
    v_mfma_f32_16x16x32_bf16 v[24:27], v[68:71], v[128:131], v[24:27]
    ds_read_b128 v[56:59], v4 offset:13312
    v_mfma_f32_16x16x32_bf16 v[28:31], v[68:71], v[132:135], v[28:31]
    v_mfma_f32_16x16x32_bf16 v[32:35], v[72:75], v[128:131], v[32:35]
    ds_read_b128 v[60:63], v7 offset:12288
    v_mfma_f32_16x16x32_bf16 v[36:39], v[72:75], v[132:135], v[36:39]
    s_waitcnt lgkmcnt(3)
    v_mfma_f32_16x16x32_bf16 v[16:19], v[40:43], v[136:139], v[16:19]
    ds_read_b128 v[64:67], v4 offset:15360
    v_mfma_f32_16x16x32_bf16 v[20:23], v[40:43], v[140:143], v[20:23]
    v_mfma_f32_16x16x32_bf16 v[24:27], v[44:47], v[136:139], v[24:27]
    ds_read_b128 v[68:71], v4 offset:16384
    v_mfma_f32_16x16x32_bf16 v[28:31], v[44:47], v[140:143], v[28:31]
    v_mfma_f32_16x16x32_bf16 v[32:35], v[48:51], v[136:139], v[32:35]
    ds_read_b128 v[72:75], v7 offset:15360
    v_mfma_f32_16x16x32_bf16 v[36:39], v[48:51], v[140:143], v[36:39]
    s_waitcnt lgkmcnt(3)
    v_mfma_f32_16x16x32_bf16 v[16:19], v[52:55], v[144:147], v[16:19]
    ds_read_b128 v[40:43], v4 offset:18432
    v_mfma_f32_16x16x32_bf16 v[20:23], v[52:55], v[148:151], v[20:23]
    v_mfma_f32_16x16x32_bf16 v[24:27], v[56:59], v[144:147], v[24:27]
    ds_read_b128 v[44:47], v4 offset:19456
    v_mfma_f32_16x16x32_bf16 v[28:31], v[56:59], v[148:151], v[28:31]
    v_mfma_f32_16x16x32_bf16 v[32:35], v[60:63], v[144:147], v[32:35]
    ds_read_b128 v[48:51], v7 offset:18432
    v_mfma_f32_16x16x32_bf16 v[36:39], v[60:63], v[148:151], v[36:39]
    s_waitcnt lgkmcnt(3)
    v_mfma_f32_16x16x32_bf16 v[16:19], v[64:67], v[152:155], v[16:19]
    ds_read_b128 v[52:55], v4 offset:21504
    v_mfma_f32_16x16x32_bf16 v[20:23], v[64:67], v[156:159], v[20:23]
    v_mfma_f32_16x16x32_bf16 v[24:27], v[68:71], v[152:155], v[24:27]
    ds_read_b128 v[56:59], v4 offset:22528
    v_mfma_f32_16x16x32_bf16 v[28:31], v[68:71], v[156:159], v[28:31]
    v_mfma_f32_16x16x32_bf16 v[32:35], v[72:75], v[152:155], v[32:35]
    ds_read_b128 v[60:63], v7 offset:21504
    v_mfma_f32_16x16x32_bf16 v[36:39], v[72:75], v[156:159], v[36:39]
    s_waitcnt lgkmcnt(3)
    v_mfma_f32_16x16x32_bf16 v[16:19], v[40:43], v[160:163], v[16:19]
    s_waitcnt vmcnt(0)
    s_barrier
    ds_read_b128 v[64:67], v4 offset:24576
    v_mfma_f32_16x16x32_bf16 v[20:23], v[40:43], v[164:167], v[20:23]
    v_mfma_f32_16x16x32_bf16 v[24:27], v[44:47], v[160:163], v[24:27]
    ds_read_b128 v[68:71], v4 offset:25600
    v_mfma_f32_16x16x32_bf16 v[28:31], v[44:47], v[164:167], v[28:31]
    v_mfma_f32_16x16x32_bf16 v[32:35], v[48:51], v[160:163], v[32:35]
    ds_read_b128 v[72:75], v7 offset:24576
    v_mfma_f32_16x16x32_bf16 v[36:39], v[48:51], v[164:167], v[36:39]
    s_waitcnt lgkmcnt(3)
    v_mfma_f32_16x16x32_bf16 v[16:19], v[52:55], v[168:171], v[16:19]
    ds_read_b128 v[40:43], v4 offset:27648
    v_mfma_f32_16x16x32_bf16 v[20:23], v[52:55], v[172:175], v[20:23]
    v_mfma_f32_16x16x32_bf16 v[24:27], v[56:59], v[168:171], v[24:27]
    ds_read_b128 v[44:47], v4 offset:28672
    v_mfma_f32_16x16x32_bf16 v[28:31], v[56:59], v[172:175], v[28:31]
    v_mfma_f32_16x16x32_bf16 v[32:35], v[60:63], v[168:171], v[32:35]
    ds_read_b128 v[48:51], v7 offset:27648
    v_mfma_f32_16x16x32_bf16 v[36:39], v[60:63], v[172:175], v[36:39]
    s_waitcnt lgkmcnt(3)
    v_mfma_f32_16x16x32_bf16 v[16:19], v[64:67], v[176:179], v[16:19]
    ds_read_b128 v[52:55], v4 offset:30720
    v_mfma_f32_16x16x32_bf16 v[20:23], v[64:67], v[180:183], v[20:23]
    v_mfma_f32_16x16x32_bf16 v[24:27], v[68:71], v[176:179], v[24:27]
    ds_read_b128 v[56:59], v4 offset:31744
    v_mfma_f32_16x16x32_bf16 v[28:31], v[68:71], v[180:183], v[28:31]
    v_mfma_f32_16x16x32_bf16 v[32:35], v[72:75], v[176:179], v[32:35]
    ds_read_b128 v[60:63], v7 offset:30720
    v_mfma_f32_16x16x32_bf16 v[36:39], v[72:75], v[180:183], v[36:39]
    s_waitcnt lgkmcnt(3)
    v_mfma_f32_16x16x32_bf16 v[16:19], v[40:43], v[184:187], v[16:19]
    ds_read_b128 v[64:67], v4 offset:33792
    v_mfma_f32_16x16x32_bf16 v[20:23], v[40:43], v[188:191], v[20:23]
    v_mfma_f32_16x16x32_bf16 v[24:27], v[44:47], v[184:187], v[24:27]
    ds_read_b128 v[68:71], v4 offset:34816
    v_mfma_f32_16x16x32_bf16 v[28:31], v[44:47], v[188:191], v[28:31]
    v_mfma_f32_16x16x32_bf16 v[32:35], v[48:51], v[184:187], v[32:35]
    ds_read_b128 v[72:75], v7 offset:33792
    v_mfma_f32_16x16x32_bf16 v[36:39], v[48:51], v[188:191], v[36:39]
    s_waitcnt lgkmcnt(3)
    v_mfma_f32_16x16x32_bf16 v[16:19], v[52:55], v[192:195], v[16:19]
    s_barrier
    ds_read_b128 v[40:43], v4 offset:36864
    v_mfma_f32_16x16x32_bf16 v[20:23], v[52:55], v[196:199], v[20:23]
    v_mfma_f32_16x16x32_bf16 v[24:27], v[56:59], v[192:195], v[24:27]
    ds_read_b128 v[44:47], v4 offset:37888
    v_mfma_f32_16x16x32_bf16 v[28:31], v[56:59], v[196:199], v[28:31]
    v_mfma_f32_16x16x32_bf16 v[32:35], v[60:63], v[192:195], v[32:35]
    ds_read_b128 v[48:51], v7 offset:36864
    v_mfma_f32_16x16x32_bf16 v[36:39], v[60:63], v[196:199], v[36:39]
    s_waitcnt lgkmcnt(3)
    v_mfma_f32_16x16x32_bf16 v[16:19], v[64:67], v[200:203], v[16:19]
    ds_read_b128 v[52:55], v4 offset:39936
    v_mfma_f32_16x16x32_bf16 v[20:23], v[64:67], v[204:207], v[20:23]
    v_mfma_f32_16x16x32_bf16 v[24:27], v[68:71], v[200:203], v[24:27]
    ds_read_b128 v[56:59], v4 offset:40960
    v_mfma_f32_16x16x32_bf16 v[28:31], v[68:71], v[204:207], v[28:31]
    v_mfma_f32_16x16x32_bf16 v[32:35], v[72:75], v[200:203], v[32:35]
    ds_read_b128 v[60:63], v7 offset:39936
    v_mfma_f32_16x16x32_bf16 v[36:39], v[72:75], v[204:207], v[36:39]
    s_waitcnt lgkmcnt(3)
    v_mfma_f32_16x16x32_bf16 v[16:19], v[40:43], v[208:211], v[16:19]
    ds_read_b128 v[64:67], v4 offset:43008
    v_mfma_f32_16x16x32_bf16 v[20:23], v[40:43], v[212:215], v[20:23]
    v_mfma_f32_16x16x32_bf16 v[24:27], v[44:47], v[208:211], v[24:27]
    ds_read_b128 v[68:71], v4 offset:44032
    v_mfma_f32_16x16x32_bf16 v[28:31], v[44:47], v[212:215], v[28:31]
    v_mfma_f32_16x16x32_bf16 v[32:35], v[48:51], v[208:211], v[32:35]
    ds_read_b128 v[72:75], v7 offset:43008
    v_mfma_f32_16x16x32_bf16 v[36:39], v[48:51], v[212:215], v[36:39]
    s_waitcnt lgkmcnt(3)
    v_mfma_f32_16x16x32_bf16 v[16:19], v[52:55], v[216:219], v[16:19]
    ds_read_b128 v[40:43], v4 offset:46080
    v_mfma_f32_16x16x32_bf16 v[20:23], v[52:55], v[220:223], v[20:23]
    v_mfma_f32_16x16x32_bf16 v[24:27], v[56:59], v[216:219], v[24:27]
    ds_read_b128 v[44:47], v4 offset:47104
    v_mfma_f32_16x16x32_bf16 v[28:31], v[56:59], v[220:223], v[28:31]
    v_mfma_f32_16x16x32_bf16 v[32:35], v[60:63], v[216:219], v[32:35]
    ds_read_b128 v[48:51], v7 offset:46080
    v_mfma_f32_16x16x32_bf16 v[36:39], v[60:63], v[220:223], v[36:39]
    s_waitcnt lgkmcnt(3)
    v_mfma_f32_16x16x32_bf16 v[16:19], v[64:67], v[224:227], v[16:19]
    ds_read_b128 v[52:55], v4 offset:49152
    v_mfma_f32_16x16x32_bf16 v[20:23], v[64:67], v[228:231], v[20:23]
    v_mfma_f32_16x16x32_bf16 v[24:27], v[68:71], v[224:227], v[24:27]
    ds_read_b128 v[56:59], v4 offset:50176
    v_mfma_f32_16x16x32_bf16 v[28:31], v[68:71], v[228:231], v[28:31]
    v_mfma_f32_16x16x32_bf16 v[32:35], v[72:75], v[224:227], v[32:35]
    ds_read_b128 v[60:63], v7 offset:49152
    v_mfma_f32_16x16x32_bf16 v[36:39], v[72:75], v[228:231], v[36:39]
    s_waitcnt lgkmcnt(3)
    v_mfma_f32_16x16x32_bf16 v[16:19], v[40:43], v[232:235], v[16:19]
    ds_read_b128 v[64:67], v4 offset:52224
    v_mfma_f32_16x16x32_bf16 v[20:23], v[40:43], v[236:239], v[20:23]
    v_mfma_f32_16x16x32_bf16 v[24:27], v[44:47], v[232:235], v[24:27]
    ds_read_b128 v[68:71], v4 offset:53248
    v_mfma_f32_16x16x32_bf16 v[28:31], v[44:47], v[236:239], v[28:31]
    v_mfma_f32_16x16x32_bf16 v[32:35], v[48:51], v[232:235], v[32:35]
    ds_read_b128 v[72:75], v7 offset:52224
    v_mfma_f32_16x16x32_bf16 v[36:39], v[48:51], v[236:239], v[36:39]
    s_waitcnt lgkmcnt(3)
    v_mfma_f32_16x16x32_bf16 v[16:19], v[52:55], v[240:243], v[16:19]
    v_mfma_f32_16x16x32_bf16 v[20:23], v[52:55], v[244:247], v[20:23]
    v_mfma_f32_16x16x32_bf16 v[24:27], v[56:59], v[240:243], v[24:27]
    v_mfma_f32_16x16x32_bf16 v[28:31], v[56:59], v[244:247], v[28:31]
    v_mfma_f32_16x16x32_bf16 v[32:35], v[60:63], v[240:243], v[32:35]
    v_mfma_f32_16x16x32_bf16 v[36:39], v[60:63], v[244:247], v[36:39]
    s_waitcnt lgkmcnt(0)
    v_mfma_f32_16x16x32_bf16 v[16:19], v[64:67], v[248:251], v[16:19]
    v_mfma_f32_16x16x32_bf16 v[20:23], v[64:67], v[252:255], v[20:23]
    v_mfma_f32_16x16x32_bf16 v[24:27], v[68:71], v[248:251], v[24:27]
    v_mfma_f32_16x16x32_bf16 v[28:31], v[68:71], v[252:255], v[28:31]
    v_mfma_f32_16x16x32_bf16 v[32:35], v[72:75], v[248:251], v[32:35]
    v_mfma_f32_16x16x32_bf16 v[36:39], v[72:75], v[252:255], v[36:39]
    s_barrier
    s_nop 5
    v_cvt_pk_bf16_f32 v60, v33, 1.0
    v_cvt_pk_bf16_f32 v61, v37, 1.0
    v_max3_f32 v12, v16, v17, v18
    v_max3_f32 v14, -v16, -v17, -v18
    v_max3_f32 v13, v20, v21, v22
    v_max3_f32 v15, -v20, -v21, -v22
    v_max3_f32 v12, v12, v19, v24
    v_max3_f32 v14, v14, -v19, -v24
    v_max3_f32 v13, v13, v23, v28
    v_max3_f32 v15, v15, -v23, -v28
    v_max3_f32 v12, v12, v25, v26
    v_max3_f32 v14, v14, -v25, -v26
    v_max3_f32 v13, v13, v29, v30
    v_max3_f32 v15, v15, -v29, -v30
    v_max3_f32 v12, v12, v27, v32
    v_max3_f32 v14, v14, -v27, -v32
    v_max3_f32 v13, v13, v31, v36
    v_max3_f32 v15, v15, -v31, -v36
    v_permlane16_swap_b32 v12, v14
    s_nop 0
    v_permlane16_swap_b32 v13, v15
    v_max_f32 v12, v12, v14
    v_max_f32 v13, v13, v15
    v_mul_f32 v14, s41, v12
    v_mul_f32 v15, s41, v13
    v_mul_f32 v12, s41, v12
    v_mul_f32 v13, s41, v13
    s_nop 0
    v_permlane16_swap_b32 v12, v14
    v_permlane16_swap_b32 v13, v15
    v_fma_f32 v76, v16, s40, v12
    v_fma_f32 v85, v16, s41, v14
    v_fma_f32 v77, v17, s40, v12
    v_fma_f32 v86, v17, s41, v14
    v_exp_f32 v76, v76
    v_exp_f32 v85, v85
    v_fma_f32 v78, v18, s40, v12
    v_fma_f32 v87, v18, s41, v14
    v_exp_f32 v77, v77
    v_exp_f32 v86, v86
    v_fma_f32 v79, v19, s40, v12
    v_fma_f32 v88, v19, s41, v14
    v_exp_f32 v78, v78
    v_exp_f32 v87, v87
    v_fma_f32 v80, v24, s40, v12
    v_fma_f32 v89, v24, s41, v14
    v_exp_f32 v79, v79
    v_exp_f32 v88, v88
    v_fma_f32 v81, v25, s40, v12
    v_fma_f32 v90, v25, s41, v14
    v_exp_f32 v80, v80
    v_exp_f32 v89, v89
    v_fma_f32 v82, v26, s40, v12
    v_fma_f32 v91, v26, s41, v14
    v_exp_f32 v81, v81
    v_exp_f32 v90, v90
    v_fma_f32 v83, v27, s40, v12
    v_fma_f32 v92, v27, s41, v14
    v_exp_f32 v82, v82
    v_exp_f32 v91, v91
    v_fma_f32 v84, v32, s40, v12
    v_fma_f32 v93, v32, s41, v14
    v_exp_f32 v83, v83
    v_exp_f32 v92, v92
    v_exp_f32 v84, v84
    v_exp_f32 v93, v93
    v_fma_f32 v94, v20, s40, v13
    v_fma_f32 v103, v20, s41, v15
    v_fma_f32 v95, v21, s40, v13
    v_fma_f32 v104, v21, s41, v15
    v_exp_f32 v94, v94
    v_exp_f32 v103, v103
    v_fma_f32 v96, v22, s40, v13
    v_fma_f32 v105, v22, s41, v15
    v_exp_f32 v95, v95
    v_exp_f32 v104, v104
    v_fma_f32 v97, v23, s40, v13
    v_fma_f32 v106, v23, s41, v15
    v_exp_f32 v96, v96
    v_exp_f32 v105, v105
    v_fma_f32 v98, v28, s40, v13
    v_fma_f32 v107, v28, s41, v15
    v_exp_f32 v97, v97
    v_exp_f32 v106, v106
    v_fma_f32 v99, v29, s40, v13
    v_fma_f32 v108, v29, s41, v15
    v_exp_f32 v98, v98
    v_exp_f32 v107, v107
    v_fma_f32 v100, v30, s40, v13
    v_fma_f32 v109, v30, s41, v15
    v_exp_f32 v99, v99
    v_exp_f32 v108, v108
    v_fma_f32 v101, v31, s40, v13
    v_fma_f32 v110, v31, s41, v15
    v_exp_f32 v100, v100
    v_exp_f32 v109, v109
    v_fma_f32 v102, v36, s40, v13
    v_fma_f32 v111, v36, s41, v15
    v_exp_f32 v101, v101
    v_exp_f32 v110, v110
    v_exp_f32 v102, v102
    v_exp_f32 v111, v111
    v_add_f32 v12, v76, v77
    v_add_f32 v14, v85, v86
    v_add_f32 v13, v94, v95
    v_add_f32 v15, v103, v104
    v_add_f32 v12, v12, v78
    v_add_f32 v14, v14, v87
    v_add_f32 v13, v13, v96
    v_add_f32 v15, v15, v105
    v_add_f32 v12, v12, v79
    v_add_f32 v14, v14, v88
    v_add_f32 v13, v13, v97
    v_add_f32 v15, v15, v106
    v_add_f32 v12, v12, v80
    v_add_f32 v14, v14, v89
    v_add_f32 v13, v13, v98
    v_add_f32 v15, v15, v107
    v_add_f32 v12, v12, v81
    v_add_f32 v14, v14, v90
    v_add_f32 v13, v13, v99
    v_add_f32 v15, v15, v108
    v_add_f32 v12, v12, v82
    v_add_f32 v14, v14, v91
    v_add_f32 v13, v13, v100
    v_add_f32 v15, v15, v109
    v_add_f32 v12, v12, v83
    v_add_f32 v14, v14, v92
    v_add_f32 v13, v13, v101
    v_add_f32 v15, v15, v110
    v_add_f32 v12, v12, v84
    v_add_f32 v14, v14, v93
    v_add_f32 v13, v13, v102
    v_add_f32 v15, v15, v111
    v_permlane16_swap_b32 v12, v14
    s_nop 0
    v_permlane16_swap_b32 v13, v15
    v_add_f32 v12, v12, v14
    v_add_f32 v13, v13, v15
    v_rcp_f32 v12, v12
    v_rcp_f32 v13, v13
    v_mov_b32 v14, v12
    v_mov_b32 v15, v13
    s_nop 0
    v_permlane16_swap_b32 v12, v14
    v_permlane16_swap_b32 v13, v15
    v_mul_f32 v76, v76, v12
    v_mul_f32 v77, v77, v12
    v_mul_f32 v78, v78, v12
    v_mul_f32 v79, v79, v12
    v_mul_f32 v80, v80, v12
    v_mul_f32 v81, v81, v12
    v_mul_f32 v82, v82, v12
    v_mul_f32 v83, v83, v12
    v_mul_f32 v84, v84, v12
    v_cvt_pk_bf16_f32 v40, v76, v77
    v_cvt_pk_bf16_f32 v41, v78, v79
    v_cvt_pk_bf16_f32 v42, v80, v81
    v_cvt_pk_bf16_f32 v43, v82, v83
    v_mul_f32 v85, v85, v14
    v_mul_f32 v86, v86, v14
    v_mul_f32 v87, v87, v14
    v_mul_f32 v88, v88, v14
    v_mul_f32 v89, v89, v14
    v_mul_f32 v90, v90, v14
    v_mul_f32 v91, v91, v14
    v_mul_f32 v92, v92, v14
    v_mul_f32 v93, v93, v14
    v_cvt_pk_bf16_f32 v44, v85, v86
    v_cvt_pk_bf16_f32 v45, v87, v88
    v_cvt_pk_bf16_f32 v46, v89, v90
    v_cvt_pk_bf16_f32 v47, v91, v92
    v_cvt_pk_bf16_f32 v48, v84, v93
    v_mul_f32 v94, v94, v13
    v_mul_f32 v95, v95, v13
    v_mul_f32 v96, v96, v13
    v_mul_f32 v97, v97, v13
    v_mul_f32 v98, v98, v13
    v_mul_f32 v99, v99, v13
    v_mul_f32 v100, v100, v13
    v_mul_f32 v101, v101, v13
    v_mul_f32 v102, v102, v13
    v_cvt_pk_bf16_f32 v50, v94, v95
    v_cvt_pk_bf16_f32 v51, v96, v97
    v_cvt_pk_bf16_f32 v52, v98, v99
    v_cvt_pk_bf16_f32 v53, v100, v101
    v_mul_f32 v103, v103, v15
    v_mul_f32 v104, v104, v15
    v_mul_f32 v105, v105, v15
    v_mul_f32 v106, v106, v15
    v_mul_f32 v107, v107, v15
    v_mul_f32 v108, v108, v15
    v_mul_f32 v109, v109, v15
    v_mul_f32 v110, v110, v15
    v_mul_f32 v111, v111, v15
    v_cvt_pk_bf16_f32 v54, v103, v104
    v_cvt_pk_bf16_f32 v55, v105, v106
    v_cvt_pk_bf16_f32 v56, v107, v108
    v_cvt_pk_bf16_f32 v57, v109, v110
    v_cvt_pk_bf16_f32 v58, v102, v111
    ds_write_b128 v8, v[40:43] offset:0
    ds_write_b32 v10, v60 offset:0
    ds_write_b128 v8, v[44:47] offset:16
    ds_write_b32 v9, v48 offset:0
    ds_write_b128 v8, v[50:53] offset:2304
    ds_write_b32 v10, v61 offset:1280
    ds_write_b128 v8, v[54:57] offset:2320
    ds_write_b32 v9, v58 offset:2304
    s_waitcnt lgkmcnt(0)
    s_barrier
    ds_read_b128 v[40:43], v3 offset:0
    ds_read_b128 v[44:47], v3 offset:1024
    ds_read_b128 v[48:51], v3 offset:2048
    ds_read_b128 v[52:55], v3 offset:3072
    ds_read_b128 v[56:59], v3 offset:4096
    ds_read_b128 v[60:63], v3 offset:5120
    s_lshl2_add_u32 s90, s33, s32
    s_lshl_b32 s90, s90, 7
    s_add_u32 s90, s90, 77824
    s_lshl2_add_u32 s52, s34, s32
    s_lshl_b32 s52, s52, 7
    s_add_u32 s52, s52, 69632
    s_mov_b32 s53, 1
    s_atomic_add s53, s[8:9], s52 glc
    v_mul_f32 v12, s41, v35
    v_mul_f32 v13, s41, v39
    v_exp_f32 v12, v12
    v_exp_f32 v13, v13
    v_add_f32 v12, 1.0, v12
    v_add_f32 v13, 1.0, v13
    v_rcp_f32 v12, v12
    v_rcp_f32 v13, v13
    v_lshrrev_b32 v4, 1, v2
    v_and_b32 v5, 1, v2
    ds_write_b32 v11, v12 offset:36864
    v_sub_f32 v35, 1.0, v12
    ds_write_b32 v11, v13 offset:36928
    v_sub_f32 v39, 1.0, v13
    v_and_b32 v14, 3, v1
    v_bfe_u32 v7, v1, 2, 1
    v_lshl_add_u32 v7, v7, 3, v14
    v_lshlrev_b32 v8, 10, v4
    v_lshl_add_u32 v8, v5, 8, v8
    v_lshl_add_u32 v8, v7, 4, v8
    v_lshlrev_b32 v9, 8, v4
    v_lshl_add_u32 v10, v5, 2, v9
    v_lshl_add_u32 v4, v14, 3, v10
    v_lshl_add_u32 v10, v7, 3, v10
    v_lshl_add_u32 v9, v5, 6, v9
    v_lshl_add_u32 v9, v14, 4, v9
    s_mov_b32 exec_lo, 0xff00ff00
    s_mov_b32 exec_hi, 0x00ff00ff
    v_mov_b32 v8, 124416
    v_mov_b32 v9, 122368
    v_mov_b32 v10, 121856
    v_mov_b32 v4, 121856
    s_mov_b64 exec, -1
    s_waitcnt lgkmcnt(6)
    v_mfma_f32_16x16x32_bf16 v[16:19], v[40:43], v[112:115], 0
    ds_read_b128 v[64:67], v3 offset:6144
    v_mfma_f32_16x16x32_bf16 v[20:23], v[40:43], v[116:119], 0
    v_mfma_f32_16x16x32_bf16 v[24:27], v[44:47], v[112:115], 0
    ds_read_b128 v[68:71], v3 offset:7168
    v_mfma_f32_16x16x32_bf16 v[28:31], v[44:47], v[116:119], 0
    s_waitcnt lgkmcnt(6)
    v_mfma_f32_16x16x32_bf16 v[16:19], v[48:51], v[120:123], v[16:19]
    ds_read_b128 v[40:43], v3 offset:8192
    v_mfma_f32_16x16x32_bf16 v[20:23], v[48:51], v[124:127], v[20:23]
    v_mfma_f32_16x16x32_bf16 v[24:27], v[52:55], v[120:123], v[24:27]
    ds_read_b128 v[44:47], v3 offset:9216
    v_mfma_f32_16x16x32_bf16 v[28:31], v[52:55], v[124:127], v[28:31]
    s_waitcnt lgkmcnt(6)
    v_mfma_f32_16x16x32_bf16 v[16:19], v[56:59], v[128:131], v[16:19]
    ds_read_b128 v[48:51], v3 offset:10240
    v_mfma_f32_16x16x32_bf16 v[20:23], v[56:59], v[132:135], v[20:23]
    v_mfma_f32_16x16x32_bf16 v[24:27], v[60:63], v[128:131], v[24:27]
    ds_read_b128 v[52:55], v3 offset:11264
    v_mfma_f32_16x16x32_bf16 v[28:31], v[60:63], v[132:135], v[28:31]
    s_waitcnt lgkmcnt(4)
    v_mfma_f32_16x16x32_bf16 v[16:19], v[64:67], v[136:139], v[16:19]
    ds_read_b128 v[56:59], v3 offset:12288
    v_mfma_f32_16x16x32_bf16 v[20:23], v[64:67], v[140:143], v[20:23]
    v_mfma_f32_16x16x32_bf16 v[24:27], v[68:71], v[136:139], v[24:27]
    ds_read_b128 v[60:63], v3 offset:13312
    v_mfma_f32_16x16x32_bf16 v[28:31], v[68:71], v[140:143], v[28:31]
    s_waitcnt lgkmcnt(4)
    v_mfma_f32_16x16x32_bf16 v[16:19], v[40:43], v[144:147], v[16:19]
    ds_read_b128 v[64:67], v3 offset:14336
    v_mfma_f32_16x16x32_bf16 v[20:23], v[40:43], v[148:151], v[20:23]
    v_mfma_f32_16x16x32_bf16 v[24:27], v[44:47], v[144:147], v[24:27]
    ds_read_b128 v[68:71], v3 offset:15360
    v_mfma_f32_16x16x32_bf16 v[28:31], v[44:47], v[148:151], v[28:31]
    s_waitcnt lgkmcnt(4)
    v_mfma_f32_16x16x32_bf16 v[16:19], v[48:51], v[152:155], v[16:19]
    ds_read_b128 v[40:43], v3 offset:16384
    v_mfma_f32_16x16x32_bf16 v[20:23], v[48:51], v[156:159], v[20:23]
    v_mfma_f32_16x16x32_bf16 v[24:27], v[52:55], v[152:155], v[24:27]
    ds_read_b128 v[44:47], v3 offset:17408
    v_mfma_f32_16x16x32_bf16 v[28:31], v[52:55], v[156:159], v[28:31]
    s_waitcnt lgkmcnt(4)
    v_mfma_f32_16x16x32_bf16 v[16:19], v[56:59], v[160:163], v[16:19]
    ds_read_b128 v[48:51], v3 offset:18432
    v_mfma_f32_16x16x32_bf16 v[20:23], v[56:59], v[164:167], v[20:23]
    v_mfma_f32_16x16x32_bf16 v[24:27], v[60:63], v[160:163], v[24:27]
    ds_read_b128 v[52:55], v3 offset:19456
    v_mfma_f32_16x16x32_bf16 v[28:31], v[60:63], v[164:167], v[28:31]
    s_waitcnt lgkmcnt(4)
    v_mfma_f32_16x16x32_bf16 v[16:19], v[64:67], v[168:171], v[16:19]
    ds_read_b128 v[56:59], v3 offset:20480
    v_mfma_f32_16x16x32_bf16 v[20:23], v[64:67], v[172:175], v[20:23]
    v_mfma_f32_16x16x32_bf16 v[24:27], v[68:71], v[168:171], v[24:27]
    ds_read_b128 v[60:63], v3 offset:21504
    v_mfma_f32_16x16x32_bf16 v[28:31], v[68:71], v[172:175], v[28:31]
    s_waitcnt lgkmcnt(4)
    v_mfma_f32_16x16x32_bf16 v[16:19], v[40:43], v[176:179], v[16:19]
    ds_read_b128 v[64:67], v3 offset:22528
    v_mfma_f32_16x16x32_bf16 v[20:23], v[40:43], v[180:183], v[20:23]
    v_mfma_f32_16x16x32_bf16 v[24:27], v[44:47], v[176:179], v[24:27]
    ds_read_b128 v[68:71], v3 offset:23552
    v_mfma_f32_16x16x32_bf16 v[28:31], v[44:47], v[180:183], v[28:31]
    s_waitcnt lgkmcnt(4)
    v_mfma_f32_16x16x32_bf16 v[16:19], v[48:51], v[184:187], v[16:19]
    ds_read_b128 v[40:43], v3 offset:24576
    v_mfma_f32_16x16x32_bf16 v[20:23], v[48:51], v[188:191], v[20:23]
    v_mfma_f32_16x16x32_bf16 v[24:27], v[52:55], v[184:187], v[24:27]
    ds_read_b128 v[44:47], v3 offset:25600
    v_mfma_f32_16x16x32_bf16 v[28:31], v[52:55], v[188:191], v[28:31]
    s_waitcnt lgkmcnt(4)
    v_mfma_f32_16x16x32_bf16 v[16:19], v[56:59], v[192:195], v[16:19]
    ds_read_b128 v[48:51], v3 offset:26624
    v_mfma_f32_16x16x32_bf16 v[20:23], v[56:59], v[196:199], v[20:23]
    v_mfma_f32_16x16x32_bf16 v[24:27], v[60:63], v[192:195], v[24:27]
    ds_read_b128 v[52:55], v3 offset:27648
    v_mfma_f32_16x16x32_bf16 v[28:31], v[60:63], v[196:199], v[28:31]
    s_waitcnt lgkmcnt(4)
    v_mfma_f32_16x16x32_bf16 v[16:19], v[64:67], v[200:203], v[16:19]
    ds_read_b128 v[56:59], v3 offset:28672
    v_mfma_f32_16x16x32_bf16 v[20:23], v[64:67], v[204:207], v[20:23]
    v_mfma_f32_16x16x32_bf16 v[24:27], v[68:71], v[200:203], v[24:27]
    ds_read_b128 v[60:63], v3 offset:29696
    v_mfma_f32_16x16x32_bf16 v[28:31], v[68:71], v[204:207], v[28:31]
    s_waitcnt lgkmcnt(4)
    v_mfma_f32_16x16x32_bf16 v[16:19], v[40:43], v[208:211], v[16:19]
    ds_read_b128 v[64:67], v3 offset:30720
    v_mfma_f32_16x16x32_bf16 v[20:23], v[40:43], v[212:215], v[20:23]
    v_mfma_f32_16x16x32_bf16 v[24:27], v[44:47], v[208:211], v[24:27]
    ds_read_b128 v[68:71], v3 offset:31744
    v_mfma_f32_16x16x32_bf16 v[28:31], v[44:47], v[212:215], v[28:31]
    s_waitcnt lgkmcnt(4)
    v_mfma_f32_16x16x32_bf16 v[16:19], v[48:51], v[216:219], v[16:19]
    ds_read_b128 v[40:43], v3 offset:32768
    v_mfma_f32_16x16x32_bf16 v[20:23], v[48:51], v[220:223], v[20:23]
    v_mfma_f32_16x16x32_bf16 v[24:27], v[52:55], v[216:219], v[24:27]
    ds_read_b128 v[44:47], v3 offset:33792
    v_mfma_f32_16x16x32_bf16 v[28:31], v[52:55], v[220:223], v[28:31]
    s_waitcnt lgkmcnt(4)
    v_mfma_f32_16x16x32_bf16 v[16:19], v[56:59], v[224:227], v[16:19]
    ds_read_b128 v[48:51], v3 offset:34816
    v_mfma_f32_16x16x32_bf16 v[20:23], v[56:59], v[228:231], v[20:23]
    v_mfma_f32_16x16x32_bf16 v[24:27], v[60:63], v[224:227], v[24:27]
    ds_read_b128 v[52:55], v3 offset:35840
    v_mfma_f32_16x16x32_bf16 v[28:31], v[60:63], v[228:231], v[28:31]
    s_waitcnt lgkmcnt(4)
    v_mfma_f32_16x16x32_bf16 v[16:19], v[64:67], v[232:235], v[16:19]
    v_mfma_f32_16x16x32_bf16 v[20:23], v[64:67], v[236:239], v[20:23]
    v_mfma_f32_16x16x32_bf16 v[24:27], v[68:71], v[232:235], v[24:27]
    v_mfma_f32_16x16x32_bf16 v[28:31], v[68:71], v[236:239], v[28:31]
    s_waitcnt lgkmcnt(2)
    v_mfma_f32_16x16x32_bf16 v[16:19], v[40:43], v[240:243], v[16:19]
    v_mfma_f32_16x16x32_bf16 v[20:23], v[40:43], v[244:247], v[20:23]
    v_mfma_f32_16x16x32_bf16 v[24:27], v[44:47], v[240:243], v[24:27]
    v_mfma_f32_16x16x32_bf16 v[28:31], v[44:47], v[244:247], v[28:31]
    s_waitcnt lgkmcnt(0)
    v_mfma_f32_16x16x32_bf16 v[16:19], v[48:51], v[248:251], v[16:19]
    v_mfma_f32_16x16x32_bf16 v[20:23], v[48:51], v[252:255], v[20:23]
    v_mfma_f32_16x16x32_bf16 v[24:27], v[52:55], v[248:251], v[24:27]
    v_mfma_f32_16x16x32_bf16 v[28:31], v[52:55], v[252:255], v[28:31]
    s_waitcnt lgkmcnt(0)
    s_sub_u32 s53, s53, s3
    s_cmp_lt_u32 s53, 0x80
    s_cbranch_scc0 L_rep3
L_ok3:
    v_mov_b32 v49, 0
    v_mov_b32 v59, 0
    v_mov_b32 v137, 0
    v_mov_b32 v139, 0
    v_mov_b32 v141, 0
    v_max3_f32 v12, v16, v17, v18
    v_max3_f32 v14, -v16, -v17, -v18
    v_max3_f32 v13, v20, v21, v22
    v_max3_f32 v15, -v20, -v21, -v22
    v_max3_f32 v12, v12, v19, v24
    v_max3_f32 v14, v14, -v19, -v24
    v_max3_f32 v13, v13, v23, v28
    v_max3_f32 v15, v15, -v23, -v28
    v_max3_f32 v12, v12, v25, v26
    v_max3_f32 v14, v14, -v25, -v26
    v_max3_f32 v13, v13, v29, v30
    v_max3_f32 v15, v15, -v29, -v30
    v_max3_f32 v12, v12, v27, v34
    v_max3_f32 v14, v14, -v27, -v34
    v_max3_f32 v13, v13, v31, v38
    v_max3_f32 v15, v15, -v31, -v38
    v_permlane16_swap_b32 v12, v14
    s_nop 0
    v_permlane16_swap_b32 v13, v15
    v_max_f32 v12, v12, v14
    v_max_f32 v13, v13, v15
    v_mul_f32 v14, s41, v12
    v_mul_f32 v15, s41, v13
    v_mul_f32 v12, s41, v12
    v_mul_f32 v13, s41, v13
    s_nop 0
    v_permlane16_swap_b32 v12, v14
    v_permlane16_swap_b32 v13, v15
    v_fma_f32 v76, v16, s40, v12
    v_fma_f32 v85, v16, s41, v14
    v_fma_f32 v77, v17, s40, v12
    v_fma_f32 v86, v17, s41, v14
    v_exp_f32 v76, v76
    v_exp_f32 v85, v85
    v_fma_f32 v78, v18, s40, v12
    v_fma_f32 v87, v18, s41, v14
    v_exp_f32 v77, v77
    v_exp_f32 v86, v86
    v_fma_f32 v79, v19, s40, v12
    v_fma_f32 v88, v19, s41, v14
    v_exp_f32 v78, v78
    v_exp_f32 v87, v87
    v_fma_f32 v80, v24, s40, v12
    v_fma_f32 v89, v24, s41, v14
    v_exp_f32 v79, v79
    v_exp_f32 v88, v88
    v_fma_f32 v81, v25, s40, v12
    v_fma_f32 v90, v25, s41, v14
    v_exp_f32 v80, v80
    v_exp_f32 v89, v89
    v_fma_f32 v82, v26, s40, v12
    v_fma_f32 v91, v26, s41, v14
    v_exp_f32 v81, v81
    v_exp_f32 v90, v90
    v_fma_f32 v83, v27, s40, v12
    v_fma_f32 v92, v27, s41, v14
    v_exp_f32 v82, v82
    v_exp_f32 v91, v91
    v_fma_f32 v84, v34, s40, v12
    v_fma_f32 v93, v34, s41, v14
    v_exp_f32 v83, v83
    v_exp_f32 v92, v92
    v_exp_f32 v84, v84
    v_exp_f32 v93, v93
    v_fma_f32 v94, v20, s40, v13
    v_fma_f32 v103, v20, s41, v15
    v_fma_f32 v95, v21, s40, v13
    v_fma_f32 v104, v21, s41, v15
    v_exp_f32 v94, v94
    v_exp_f32 v103, v103
    v_fma_f32 v96, v22, s40, v13
    v_fma_f32 v105, v22, s41, v15
    v_exp_f32 v95, v95
    v_exp_f32 v104, v104
    v_fma_f32 v97, v23, s40, v13
    v_fma_f32 v106, v23, s41, v15
    v_exp_f32 v96, v96
    v_exp_f32 v105, v105
    v_fma_f32 v98, v28, s40, v13
    v_fma_f32 v107, v28, s41, v15
    v_exp_f32 v97, v97
    v_exp_f32 v106, v106
    v_fma_f32 v99, v29, s40, v13
    v_fma_f32 v108, v29, s41, v15
    v_exp_f32 v98, v98
    v_exp_f32 v107, v107
    v_fma_f32 v100, v30, s40, v13
    v_fma_f32 v109, v30, s41, v15
    v_exp_f32 v99, v99
    v_exp_f32 v108, v108
    v_fma_f32 v101, v31, s40, v13
    v_fma_f32 v110, v31, s41, v15
    v_exp_f32 v100, v100
    v_exp_f32 v109, v109
    v_fma_f32 v102, v38, s40, v13
    v_fma_f32 v111, v38, s41, v15
    v_exp_f32 v101, v101
    v_exp_f32 v110, v110
    v_exp_f32 v102, v102
    v_exp_f32 v111, v111
    v_add_f32 v12, v76, v77
    v_add_f32 v14, v85, v86
    v_add_f32 v13, v94, v95
    v_add_f32 v15, v103, v104
    v_add_f32 v12, v12, v78
    v_add_f32 v14, v14, v87
    v_add_f32 v13, v13, v96
    v_add_f32 v15, v15, v105
    v_add_f32 v12, v12, v79
    v_add_f32 v14, v14, v88
    v_add_f32 v13, v13, v97
    v_add_f32 v15, v15, v106
    v_add_f32 v12, v12, v80
    v_add_f32 v14, v14, v89
    v_add_f32 v13, v13, v98
    v_add_f32 v15, v15, v107
    v_add_f32 v12, v12, v81
    v_add_f32 v14, v14, v90
    v_add_f32 v13, v13, v99
    v_add_f32 v15, v15, v108
    v_add_f32 v12, v12, v82
    v_add_f32 v14, v14, v91
    v_add_f32 v13, v13, v100
    v_add_f32 v15, v15, v109
    v_add_f32 v12, v12, v83
    v_add_f32 v14, v14, v92
    v_add_f32 v13, v13, v101
    v_add_f32 v15, v15, v110
    v_add_f32 v12, v12, v84
    v_add_f32 v14, v14, v93
    v_add_f32 v13, v13, v102
    v_add_f32 v15, v15, v111
    v_permlane16_swap_b32 v12, v14
    s_nop 0
    v_permlane16_swap_b32 v13, v15
    v_add_f32 v12, v12, v14
    v_add_f32 v13, v13, v15
    v_rcp_f32 v12, v12
    v_rcp_f32 v13, v13
    v_mov_b32 v14, v12
    v_mov_b32 v15, v13
    s_nop 0
    v_permlane16_swap_b32 v12, v14
    v_permlane16_swap_b32 v13, v15
    v_mul_f32 v76, v76, v12
    v_mul_f32 v77, v77, v12
    v_mul_f32 v78, v78, v12
    v_mul_f32 v79, v79, v12
    v_mul_f32 v80, v80, v12
    v_mul_f32 v81, v81, v12
    v_mul_f32 v82, v82, v12
    v_mul_f32 v83, v83, v12
    v_mul_f32 v84, v84, v12
    v_cvt_pk_bf16_f32 v40, v76, v77
    v_cvt_pk_bf16_f32 v41, v78, v79
    v_cvt_pk_bf16_f32 v42, v80, v81
    v_cvt_pk_bf16_f32 v43, v82, v83
    v_mul_f32 v85, v85, v14
    v_mul_f32 v86, v86, v14
    v_mul_f32 v87, v87, v14
    v_mul_f32 v88, v88, v14
    v_mul_f32 v89, v89, v14
    v_mul_f32 v90, v90, v14
    v_mul_f32 v91, v91, v14
    v_mul_f32 v92, v92, v14
    v_mul_f32 v93, v93, v14
    v_cvt_pk_bf16_f32 v44, v85, v86
    v_cvt_pk_bf16_f32 v45, v87, v88
    v_cvt_pk_bf16_f32 v46, v89, v90
    v_cvt_pk_bf16_f32 v47, v91, v92
    v_cvt_pk_bf16_f32 v48, v84, v93
    v_mul_f32 v94, v94, v13
    v_mul_f32 v95, v95, v13
    v_mul_f32 v96, v96, v13
    v_mul_f32 v97, v97, v13
    v_mul_f32 v98, v98, v13
    v_mul_f32 v99, v99, v13
    v_mul_f32 v100, v100, v13
    v_mul_f32 v101, v101, v13
    v_mul_f32 v102, v102, v13
    v_cvt_pk_bf16_f32 v50, v94, v95
    v_cvt_pk_bf16_f32 v51, v96, v97
    v_cvt_pk_bf16_f32 v52, v98, v99
    v_cvt_pk_bf16_f32 v53, v100, v101
    v_mul_f32 v103, v103, v15
    v_mul_f32 v104, v104, v15
    v_mul_f32 v105, v105, v15
    v_mul_f32 v106, v106, v15
    v_mul_f32 v107, v107, v15
    v_mul_f32 v108, v108, v15
    v_mul_f32 v109, v109, v15
    v_mul_f32 v110, v110, v15
    v_mul_f32 v111, v111, v15
    v_cvt_pk_bf16_f32 v54, v103, v104
    v_cvt_pk_bf16_f32 v55, v105, v106
    v_cvt_pk_bf16_f32 v56, v107, v108
    v_cvt_pk_bf16_f32 v57, v109, v110
    v_cvt_pk_bf16_f32 v58, v102, v111
    s_barrier
    ds_read_b128 v[128:131], v9 offset:39424
    ds_read_b128 v[132:135], v9 offset:39552
    ds_read_b32 v140, v4 offset:40064
    ds_read_b128 v[112:115], v8 offset:37376
    ds_read_b128 v[116:119], v8 offset:37888
    ds_read_b32 v136, v10 offset:39936
    ds_read_b128 v[120:123], v8 offset:37440
    ds_read_b128 v[124:127], v8 offset:37952
    ds_read_b32 v138, v10 offset:39968
    s_waitcnt lgkmcnt(6)
    v_mfma_f32_16x16x32_bf16 v[160:163], v[128:131], v[40:43], 0
    v_mfma_f32_16x16x32_bf16 v[164:167], v[128:131], v[50:53], 0
    v_mfma_f32_16x16x32_bf16 v[160:163], v[132:135], v[44:47], v[160:163]
    v_mfma_f32_16x16x32_bf16 v[164:167], v[132:135], v[54:57], v[164:167]
    v_mfma_f32_16x16x16_bf16 v[160:163], v[140:141], v[48:49], v[160:163]
    v_mfma_f32_16x16x16_bf16 v[164:167], v[140:141], v[58:59], v[164:167]
    s_waitcnt lgkmcnt(3)
    v_mfma_f32_16x16x32_bf16 v[144:147], v[112:115], v[40:43], 0
    v_mfma_f32_16x16x32_bf16 v[148:151], v[112:115], v[50:53], 0
    v_mfma_f32_16x16x32_bf16 v[144:147], v[116:119], v[44:47], v[144:147]
    v_mfma_f32_16x16x32_bf16 v[148:151], v[116:119], v[54:57], v[148:151]
    v_mfma_f32_16x16x16_bf16 v[144:147], v[136:137], v[48:49], v[144:147]
    v_mfma_f32_16x16x16_bf16 v[148:151], v[136:137], v[58:59], v[148:151]
    v_add_f32 v12, 0x358637bd, v161
    v_add_f32 v13, 0x358637bd, v165
    v_rcp_f32 v12, v12
    v_rcp_f32 v13, v13
    v_mul_f32 v12, v12, v35
    v_mul_f32 v13, v13, v39
    s_waitcnt lgkmcnt(0)
    v_mfma_f32_16x16x32_bf16 v[152:155], v[120:123], v[40:43], 0
    v_mfma_f32_16x16x32_bf16 v[156:159], v[120:123], v[50:53], 0
    v_mfma_f32_16x16x32_bf16 v[152:155], v[124:127], v[44:47], v[152:155]
    v_mfma_f32_16x16x32_bf16 v[156:159], v[124:127], v[54:57], v[156:159]
    v_mfma_f32_16x16x16_bf16 v[152:155], v[138:139], v[48:49], v[152:155]
    v_mfma_f32_16x16x16_bf16 v[156:159], v[138:139], v[58:59], v[156:159]
    v_mul_f32 v160, v160, v12
    v_mul_f32 v162, v162, v12
    v_cvt_pk_bf16_f32 v160, v160, v162
    v_mul_f32 v164, v164, v13
    v_mul_f32 v166, v166, v13
    v_cvt_pk_bf16_f32 v164, v164, v166
    v_cndmask_b32 v14, v160, v164, s[56:57]
    v_mul_f32 v144, v144, v12
    v_mul_f32 v145, v145, v12
    v_mul_f32 v146, v146, v12
    v_mul_f32 v147, v147, v12
    v_cvt_pk_bf16_f32 v176, v144, v145
    v_cvt_pk_bf16_f32 v177, v146, v147
    v_mul_f32 v152, v152, v12
    v_mul_f32 v153, v153, v12
    v_mul_f32 v154, v154, v12
    v_mul_f32 v155, v155, v12
    v_cvt_pk_bf16_f32 v178, v152, v153
    v_cvt_pk_bf16_f32 v179, v154, v155
    v_permlane32_swap_b32 v14, v15
    buffer_store_dwordx4 v[176:179], v3, s[8:11], s46 offen sc1
    v_mul_f32 v148, v148, v13
    v_mul_f32 v149, v149, v13
    v_mul_f32 v150, v150, v13
    v_mul_f32 v151, v151, v13
    v_cvt_pk_bf16_f32 v180, v148, v149
    v_cvt_pk_bf16_f32 v181, v150, v151
    v_mul_f32 v156, v156, v13
    v_mul_f32 v157, v157, v13
    v_mul_f32 v158, v158, v13
    v_mul_f32 v159, v159, v13
    v_cvt_pk_bf16_f32 v182, v156, v157
    v_cvt_pk_bf16_f32 v183, v158, v159
    buffer_store_dwordx4 v[180:183], v3, s[8:11], s88 offen sc1
    s_mov_b32 exec_hi, 0
    buffer_store_dwordx2 v[14:15], v6, s[8:11], s89 offen sc1
    s_barrier
    s_barrier
    s_endpgm
L_rep1:
    s_cmp_lt_u32 s52, 0x80
    s_cselect_b32 s53, 0, 1
L_chk1:
    s_sub_u32 s58, s58, 1
    s_cbranch_scc1 L_giveup1
    s_mov_b32 s52, s53
    s_atomic_add s52, s[8:9], s90 glc
    s_waitcnt lgkmcnt(0)
    s_sub_u32 s52, s52, s3
    s_cmp_lt_u32 s52, 0x80
    s_cbranch_scc0 L_chk1
    s_add_u32 s52, s52, s53
    s_mov_b32 s53, 0
    s_cmp_ge_u32 s52, 0
    s_cbranch_scc0 L_chk1
    s_branch L_ok1
L_giveup1:
    s_mov_b32 s58, 0
    s_branch L_ok1
L_rep2:
    s_cmp_lt_u32 s52, 0x80
    s_cselect_b32 s53, 0, 0
L_chk2:
    s_sub_u32 s58, s58, 1
    s_cbranch_scc1 L_giveup2
    s_mov_b32 s52, s53
    s_atomic_add s52, s[8:9], s91 glc
    s_waitcnt lgkmcnt(0)
    s_sub_u32 s52, s52, s3
    s_cmp_lt_u32 s52, 0x80
    s_cbranch_scc0 L_chk2
    s_add_u32 s52, s52, s53
    s_mov_b32 s53, 0
    s_cmp_ge_u32 s52, s55
    s_cbranch_scc0 L_chk2
    s_branch L_ok2
L_giveup2:
    s_mov_b32 s58, 0
    s_branch L_ok2
L_T_w0:
    s_waitcnt lgkmcnt(0)
    s_sub_u32 s38, s52, s3
    s_cmp_eq_u32 s38, s55
    s_cbranch_scc1 L_T_early
    s_mov_b32 s52, 0
    s_atomic_add s52, s[8:9], s91 glc
    s_branch L_T_rest
L_T_early:
    s_mov_b32 s54, 1
    s_call_b64 s[44:45], L_kdma
    s_waitcnt vmcnt(10)
    s_barrier
    ds_read_b128 v[224:227], v4 offset:32768
    ds_read_b128 v[228:231], v4 offset:34816
    ds_read_b128 v[232:235], v5 offset:32768
    ds_read_b128 v[236:239], v5 offset:34816
    s_mov_b32 s54, 1
    s_call_b64 s[44:45], L_kdma
    s_waitcnt vmcnt(12)
    s_barrier
    ds_read_b128 v[240:243], v4 offset:49152
    ds_read_b128 v[244:247], v4 offset:51200
    ds_read_b128 v[248:251], v5 offset:49152
    ds_read_b128 v[252:255], v5 offset:51200
    s_mov_b32 s54, 7
    s_call_b64 s[44:45], L_kdma
    s_branch L_T_k
L_kdma:
    s_mov_b32 m0, s29
    s_add_u32 s38, s30, s28
    buffer_load_dwordx4 v3, s[8:11], s38 offen offset:0 sc1 lds
    buffer_load_dwordx4 v3, s[8:11], s38 offen offset:1024 sc1 lds
    buffer_load_dwordx4 v3, s[8:11], s38 offen offset:2048 sc1 lds
    s_add_u32 s29, s29, 3072
    s_add_u32 s28, s28, 3072
    s_sub_u32 s38, s28, 55296
    s_cselect_b32 s28, s28, s38
    s_sub_u32 s54, s54, 1
    s_cbranch_scc0 L_kdma
    s_setpc_b64 s[44:45]
L_rep3:
    s_cmp_lt_u32 s53, 0x80
    s_cselect_b32 s54, 0, 1
L_chk3:
    s_sub_u32 s58, s58, 1
    s_cbranch_scc1 L_giveup3
    s_mov_b32 s53, s54
    s_atomic_add s53, s[8:9], s52 glc
    s_waitcnt lgkmcnt(0)
    s_sub_u32 s53, s53, s3
    s_cmp_lt_u32 s53, 0x80
    s_cbranch_scc0 L_chk3
    s_add_u32 s53, s53, s54
    s_mov_b32 s54, 0
    s_cmp_ge_u32 s53, 0
    s_cbranch_scc0 L_chk3
    s_branch L_ok3
L_giveup3:
    s_mov_b32 s58, 0
    s_branch L_ok3
L_N1:
    s_and_b32 s38, s2, 3
    s_bfe_u32 s39, s2, 0x20003
    s_lshl2_add_u32 s33, s38, s39
    s_bfe_u32 s38, s2, 0x10002
    s_lshr_b32 s39, s2, 5
    s_lshl3_add_u32 s34, s38, s39
    s_lshl1_add_u32 s35, s33, s34
    s_mul_i32 s38, s35, 57
    s_lshr_b32 s38, s38, 9
    s_mul_i32 s38, s38, 9
    s_sub_u32 s35, s35, s38
    s_lshl4_add_u32 s37, s33, s34
    s_mov_b32 s10, 8757248
    s_mov_b32 s58, 1048576
    s_lshr_b32 s38, s33, 1
    s_add_u32 s40, s38, 1
    s_and_b32 s40, s40, 7
    s_sub_u32 s38, 15, s38
    s_bitcmp1_b32 s33, 0
    s_cselect_b32 s40, s38, s40
    s_and_b32 s32, s32, 3
    s_lshl_b32 s44, s32, 12
    s_and_b32 s41, s34, 7
    s_lshr_b32 s42, s32, 1
    s_and_b32 s43, s32, 1
    v_min_u32 v5, 59, v0
    v_mul_u32_u24 v6, 13, v5
    v_lshrrev_b32 v6, 8, v6
    v_mul_u32_u24 v7, 20, v6
    v_sub_u32 v7, v5, v7
    v_cmp_ne_u32 vcc, 19, v7
    s_mul_i32 s38, s34, 18
    v_add_u32 v4, s38, v7
    v_cvt_f32_u32 v114, v4
    v_mul_f32 v114, 0xbae38e39, v114
    v_cos_f32 v113, v114
    s_mul_i32 s38, s32, 3
    v_add_u32 v6, s38, v6
    v_lshrrev_b32 v5, 2, v6
    v_mul_u32_u24 v5, 2560, v5
    v_lshl_add_u32 v5, v7, 4, v5
    v_and_b32 v8, 3, v6
    v_lshl_add_u32 v115, v8, 8, v5
    v_add_u32 v116, 1024, v115
    v_lshl_add_u32 v5, v8, 7, v5
    v_cmp_gt_u32 s[46:47], 16, v7
    v_add_u32 v8, 1856, v5
    v_add_u32 v5, 1792, v5
    v_cndmask_b32 v115, v5, v115, s[46:47]
    v_cndmask_b32 v116, v8, v116, s[46:47]
    s_lshl_b32 s38, s35, 6
    s_add_u32 s39, s38, 288
    s_sub_u32 s38, s38, 288
    s_cselect_b32 s38, s39, s38
    v_lshl_add_u32 v6, v6, 3, s38
    v_add_f32 v113, v113, v113
    s_mov_b32 s38, 2
    s_waitcnt lgkmcnt(0)
    s_load_dword s36, s[8:9], 0
    s_load_dwordx2 s[28:29], s[0:1], 80
L_gen:
    v_mul_u32_u24 v5, v6, v4
    v_cvt_f32_u32 v112, v5
    v_mul_f32 v112, 0xbae38e39, v112
    v_fract_f32 v112, v112
    v_add_f32 v117, v112, v114
    v_cos_f32 v128, v112
    v_cos_f32 v129, v117
    v_sin_f32 v120, v112
    v_sin_f32 v121, v117
    v_add_u32 v6, 96, v6
    v_cndmask_b32 v128, 0, v128, vcc
    v_cndmask_b32 v129, 0, v129, vcc
    v_cndmask_b32 v120, 0, v120, vcc
    v_cndmask_b32 v121, 0, v121, vcc
    v_fma_f32 v130, v113, v129, -v128
    v_fma_f32 v122, v113, v121, -v120
    v_fma_f32 v131, v113, v130, -v129
    v_fma_f32 v123, v113, v122, -v121
    v_fma_f32 v132, v113, v131, -v130
    v_fma_f32 v124, v113, v123, -v122
    v_fma_f32 v133, v113, v132, -v131
    v_fma_f32 v125, v113, v124, -v123
    v_fma_f32 v134, v113, v133, -v132
    v_fma_f32 v126, v113, v125, -v124
    v_fma_f32 v135, v113, v134, -v133
    v_fma_f32 v127, v113, v126, -v125
    v_cvt_pk_bf16_f32 v136, v128, v129
    v_cvt_pk_bf16_f32 v140, v120, v121
    v_cvt_pk_bf16_f32 v137, v130, v131
    v_cvt_pk_bf16_f32 v141, v122, v123
    v_cvt_pk_bf16_f32 v138, v132, v133
    v_cvt_pk_bf16_f32 v142, v124, v125
    v_cvt_pk_bf16_f32 v139, v134, v135
    v_cvt_pk_bf16_f32 v143, v126, v127
    ds_write_b128 v115, v[136:139]
    ds_write_b128 v116, v[140:143]
    v_add_u32 v115, 7680, v115
    v_add_u32 v116, 7680, v116
    s_sub_u32 s38, s38, 1
    s_cbranch_scc0 L_gen
    v_lshrrev_b32 v4, 1, v1
    v_xor_b32 v4, v4, v2
    v_lshlrev_b32 v4, 4, v4
    v_lshl_add_u32 v4, v1, 7, v4
    s_lshl_b32 s38, s32, 12
    s_add_u32 s38, s38, 31232
    v_add_u32 v4, s38, v4
    v_xor_b32 v5, 64, v4
    v_and_b32 v10, 7, v1
    v_min_u32 v10, 3, v10
    v_lshrrev_b32 v12, 3, v1
    v_lshl_add_u32 v10, v12, 2, v10
    v_lshlrev_b32 v10, 4, v10
    v_lshl_add_u32 v10, v2, 7, v10
    v_lshlrev_b32 v110, 31, v1
    v_or_b32 v110, 1.0, v110
    s_mul_i32 s38, s32, 2560
    s_add_u32 s38, s38, 141824
    v_mul_u32_u24 v104, 80, v1
    v_lshl_add_u32 v104, v2, 4, v104
    v_add_u32 v104, s38, v104
    s_lshl2_add_u32 s38, s32, 152064
    v_mul_u32_u24 v111, 352, v2
    v_add3_u32 v111, v111, v3, s38
    v_lshrrev_b32 v12, 2, v0
    v_and_b32 v13, 3, v0
    v_mul_u32_u24 v107, 160, v12
    v_mul_u32_u24 v106, 288, v12
    v_lshl_add_u32 v105, v13, 3, v106
    s_lshl_b32 s38, s42, 6
    s_add_u32 s38, s38, 123392
    v_add_u32 v105, s38, v105
    s_lshl3_add_u32 s39, s42, 123520
    v_add_u32 v106, s39, v106
    s_lshl3_add_u32 s38, s42, 141888
    s_lshl_b32 s39, s42, 5
    s_add_u32 s39, s39, 141824
    s_cmp_eq_u32 s43, 0
    s_cselect_b32 s38, s39, s38
    s_cselect_b32 s39, 8, 0
    s_cselect_b32 s47, 0, -192
    v_add_u32 v107, s38, v107
    v_mad_u32_u24 v107, v13, s39, v107
    v_mad_i32_i24 v108, v2, s47, v3
    v_lshlrev_b32 v109, 3, v1
    s_lshl_b32 s48, s32, 10
    s_bfe_u32 s5, s34, 65539
    s_cmp_gt_u32 s40, 8
    s_cselect_b32 s39, 1, 0
    s_xor_b32 s39, s39, s5
    s_lshl4_add_u32 s4, s39, s40
    s_lshl_b32 s38, s43, 10
    s_lshl_b32 s39, s42, 5
    s_add_u32 s38, s38, s39
    s_add_u32 s27, s38, s4
    s_sub_u32 s38, 7, s41
    s_min_u32 s6, s38, s41
    v_lshrrev_b32 v14, 2, v1
    s_lshl_b32 s38, s32, 13
    s_add_u32 s38, s38, 32768
    s_mul_i32 s39, s6, 57
    s_lshr_b32 s39, s39, 4
    v_min_u32 v8, 4, v1
    v_add_u32 v8, s39, v8
    v_cmp_gt_u32 vcc, 14, v1
    v_lshl_add_u32 v12, v2, 11, s38
    s_nop 0
    v_cndmask_b32 v8, v1, v8, vcc
    v_lshl_add_u32 v8, v8, 7, v12
    v_mul_u32_u24 v14, 1040, v14
    v_lshl_add_u32 v14, v13, 6, v14
    s_mov_b32 s38, 40448
    v_lshlrev_b32 v68, 8, v2
    v_add3_u32 v68, v68, v14, s38
    v_xor_b32 v69, 16, v68
    s_mov_b32 s30, 2359296
    s_mov_b32 s31, s11
    s_lshr_b32 s46, s2, 1
    s_and_b32 s46, s46, 0x7c
    s_and_b32 s57, s2, 3
    s_or_b32 s46, s46, s57
    s_lshl2_add_u32 s46, s46, s32
    s_bitcmp1_b32 s2, 2
    s_cselect_b32 s46, 160, s46
    s_waitcnt lgkmcnt(0)
    s_add_u32 s36, s36, 0x9e3779b9
    s_and_b32 s3, s36, 0xffffff80
    s_cmp_ge_u32 s46, 160
    s_cbranch_scc1 L_N_noinit
    s_lshl_b32 s46, s46, 7
    s_add_u32 s46, s46, 65536
    s_mov_b32 s57, s3
    s_atomic_swap s57, s[8:9], s46 glc
L_N_noinit:
    v_xor_b32 v70, 32, v68
    v_xor_b32 v71, 48, v68
    v_mul_u32_u24 v9, 2816, v2
    v_add_u32 v9, v9, v3
    v_mov_b32 v56, 0
    v_mov_b32 v57, 0
    v_mov_b32 v58, 0
    v_mov_b32 v59, 0
    s_mov_b64 s[38:39], 0x3f80
    s_mov_b32 exec_lo, 0x000f000f
    s_mov_b32 exec_hi, exec_lo
    v_lshlrev_b64 v[56:57], v3, s[38:39]
    s_lshl_b64 exec, exec, 4
    v_lshlrev_b64 v[58:59], v3, s[38:39]
    s_mov_b64 exec, -1
    s_lshl_b32 s38, s42, 10
    s_add_u32 s38, s38, 37376
    v_add_u32 v60, s38, v3
    v_add_u32 v61, 8, v60
    v_add_u32 v62, 512, v60
    s_cmp_eq_u32 s43, 0
    s_cbranch_scc1 L_N_even
    v_add_u32 v60, 520, v60
    s_lshl_b32 s38, s42, 8
    s_add_u32 s39, s38, 39424
    v_and_b32 v61, 11, v1
    v_lshl_add_u32 v61, v2, 2, v61
    v_lshl_add_u32 v61, v61, 4, s39
    v_and_b32 v62, 4, v1
    v_lshl_add_u32 v61, v62, 1, v61
    s_add_u32 s39, s38, 39936
    v_lshl_add_u32 v62, v1, 4, s39
    v_lshl_add_u32 v62, v2, 3, v62
L_N_even:
    s_cmp_ge_u32 s41, 4
    s_cselect_b32 s38, 63, 0
    s_lshl_b32 s7, s38, 31
    s_or_b32 s7, s7, 0x3a000000
    s_movk_i32 s47, 9440
    s_lshl_b32 s39, s6, 6
    v_mov_b32 v72, s39
    v_mul_u32_u24 v14, 155648, v2
    s_xor_b32 s39, s38, 0
    v_xad_u32 v12, v1, s39, v72
    v_mul_u32_u24 v13, 3641, v12
    v_lshrrev_b32 v13, 16, v13
    v_mad_u32_u24 v13, v13, s47, v14
    v_lshl_add_u32 v63, v12, 4, v13
    s_xor_b32 s39, s38, 17
    v_xad_u32 v12, v1, s39, v72
    v_mul_u32_u24 v13, 3641, v12
    v_lshrrev_b32 v13, 16, v13
    v_mad_u32_u24 v13, v13, s47, v14
    v_lshl_add_u32 v64, v12, 4, v13
    s_xor_b32 s39, s38, 34
    v_xad_u32 v12, v1, s39, v72
    v_mul_u32_u24 v13, 3641, v12
    v_lshrrev_b32 v13, 16, v13
    v_mad_u32_u24 v13, v13, s47, v14
    v_lshl_add_u32 v65, v12, 4, v13
    s_xor_b32 s39, s38, 51
    v_xad_u32 v12, v1, s39, v72
    v_mul_u32_u24 v13, 3641, v12
    v_lshrrev_b32 v13, 16, v13
    v_mad_u32_u24 v13, v13, s47, v14
    v_lshl_add_u32 v66, v12, 4, v13
    s_lshl3_add_u32 s39, s6, 256
    v_mov_b32 v72, s39
    v_and_b32 v73, 7, v0
    v_bfe_u32 v14, v0, 3, 2
    v_mul_u32_u24 v14, 155648, v14
    s_and_b32 s39, s38, 7
    v_xad_u32 v12, v73, s39, v72
    v_mul_u32_u24 v13, 3641, v12
    v_lshrrev_b32 v13, 16, v13
    v_mad_u32_u24 v13, v13, s47, v14
    v_lshl_add_u32 v67, v12, 4, v13
    v_mul_u32_u24 v13, 294912, v2
    s_lshl4_add_u32 s38, s41, 512
    v_lshl_add_u32 v14, v1, 1, s38
    v_add_u32 v14, v14, v13
    s_lshr_b32 s38, s41, 2
    s_add_u32 s38, s38, s41
    s_lshl_b32 s38, s38, 7
    v_add3_u32 v13, v109, v13, s38
    v_lshrrev_b32 v12, 5, v0
    v_mul_u32_u24 v12, 18304, v12
    v_lshl_add_u32 v12, v0, 2, v12
    s_waitcnt vmcnt(0)
    v_lshl_add_u32 v11, v1, 6, s27
    v_cvt_f32_u32 v11, v11
    v_mul_f32 v11, s7, v11
    v_lshlrev_b32 v7, 31, v2
    v_xor_b32 v6, v7, v11
    v_lshrrev_b32 v15, 1, v2
    v_add_u32 v15, 1, v15
    v_cvt_f32_u32 v15, v15
    v_mul_f32 v15, v15, v6
    v_ashrrev_i32 v7, 31, v7
    v_and_b32 v7, v7, v11
    v_fmamk_f32 v15, v7, 0x41800000, v15
    v_mul_f32 v11, 0x41800000, v11
    v_cos_f32 v7, v11
    v_cmp_ne_u32 vcc, 2, v2
    v_add_f32 v7, v7, v7
    v_add_f32 v73, v15, v11
    v_cos_f32 v76, v15
    v_sin_f32 v72, v15
    v_cos_f32 v77, v73
    v_sin_f32 v73, v73
    v_fma_f32 v78, v7, v77, -v76
    v_fma_f32 v74, v7, v73, -v72
    v_fma_f32 v79, v7, v78, -v77
    v_fma_f32 v75, v7, v74, -v73
    v_cvt_pk_bf16_f32 v40, v76, v72
    v_cvt_pk_bf16_f32 v41, v77, v73
    v_cvt_pk_bf16_f32 v42, v78, v74
    v_cvt_pk_bf16_f32 v43, v79, v75
    v_fma_f32 v15, 2.0, v6, v15
    v_add_f32 v73, v15, v11
    v_cos_f32 v76, v15
    v_sin_f32 v72, v15
    v_cos_f32 v77, v73
    v_sin_f32 v73, v73
    v_fma_f32 v78, v7, v77, -v76
    v_fma_f32 v74, v7, v73, -v72
    v_fma_f32 v79, v7, v78, -v77
    v_fma_f32 v75, v7, v74, -v73
    v_cvt_pk_bf16_f32 v44, v76, v72
    v_cvt_pk_bf16_f32 v45, v77, v73
    v_cvt_pk_bf16_f32 v46, v78, v74
    v_cvt_pk_bf16_f32 v47, v79, v75
    v_fma_f32 v15, 2.0, v6, v15
    v_add_f32 v73, v15, v11
    v_cos_f32 v76, v15
    v_sin_f32 v72, v15
    v_cos_f32 v77, v73
    v_sin_f32 v73, v73
    v_fma_f32 v78, v7, v77, -v76
    v_fma_f32 v74, v7, v73, -v72
    v_fma_f32 v79, v7, v78, -v77
    v_fma_f32 v75, v7, v74, -v73
    v_cvt_pk_bf16_f32 v48, v76, v72
    v_cvt_pk_bf16_f32 v49, v77, v73
    v_cvt_pk_bf16_f32 v50, v78, v74
    v_cvt_pk_bf16_f32 v51, v79, v75
    v_fma_f32 v15, 2.0, v6, v15
    v_cndmask_b32 v15, 0, v15, vcc
    v_add_f32 v73, v15, v11
    v_cos_f32 v76, v15
    v_sin_f32 v72, v15
    v_cos_f32 v77, v73
    v_sin_f32 v73, v73
    v_fma_f32 v78, v7, v77, -v76
    v_fma_f32 v74, v7, v73, -v72
    v_fma_f32 v79, v7, v78, -v77
    v_fma_f32 v75, v7, v74, -v73
    v_cvt_pk_bf16_f32 v52, v76, v72
    v_cvt_pk_bf16_f32 v53, v77, v73
    v_cvt_pk_bf16_f32 v54, v78, v74
    v_cvt_pk_bf16_f32 v55, v79, v75
    v_add_u32 v6, s48, v3
    v_cmp_gt_u32 vcc, 1536, v6
    v_add_u32 v7, 152064, v6
    s_nop 0
    v_cndmask_b32 v11, -16, v6, vcc
    v_cndmask_b32 v15, v6, v7, vcc
    s_waitcnt lgkmcnt(0)
    s_barrier
    ds_read_b128 v[112:115], v4 offset:49152
    ds_read_b128 v[116:119], v4 offset:51200
    ds_read_b128 v[120:123], v5 offset:49152
    ds_read_b128 v[124:127], v5 offset:51200
    ds_read_b128 v[80:83], v3 offset:0
    ds_read_b128 v[84:87], v3 offset:1024
    ds_read_b128 v[88:91], v10 offset:2048
    ds_read_b128 v[92:95], v3 offset:2560
    ds_read_b128 v[96:99], v3 offset:3584
    ds_read_b128 v[100:103], v10 offset:4608
    s_waitcnt lgkmcnt(6)
    s_waitcnt lgkmcnt(3)
    v_mfma_f32_16x16x32_bf16 v[16:19], v[112:115], v[80:83], 0
    s_barrier
    v_mfma_f32_16x16x32_bf16 v[20:23], v[116:119], v[80:83], 0
    ds_read_b128 v[80:83], v3 offset:5120
    ds_read_b128 v[128:131], v4 offset:0
    v_mfma_f32_16x16x32_bf16 v[24:27], v[112:115], v[84:87], 0
    ds_read_b128 v[132:135], v4 offset:2048
    v_mfma_f32_16x16x32_bf16 v[28:31], v[116:119], v[84:87], 0
    ds_read_b128 v[84:87], v3 offset:6144
    ds_read_b128 v[136:139], v5 offset:0
    v_mfma_f32_16x16x32_bf16 v[32:35], v[112:115], v[88:91], 0
    ds_read_b128 v[140:143], v5 offset:2048
    v_mfma_f32_16x16x32_bf16 v[36:39], v[116:119], v[88:91], 0
    ds_read_b128 v[88:91], v10 offset:7168
    s_waitcnt lgkmcnt(7)
    v_mfma_f32_16x16x32_bf16 v[16:19], v[120:123], v[92:95], v[16:19]
    s_mul_i32 s49, s34, 36864
    v_mfma_f32_16x16x32_bf16 v[20:23], v[124:127], v[92:95], v[20:23]
    ds_read_b128 v[92:95], v3 offset:7680
    v_mfma_f32_16x16x32_bf16 v[24:27], v[120:123], v[96:99], v[24:27]
    s_add_u32 s50, s49, 1867776
    v_mfma_f32_16x16x32_bf16 v[28:31], v[124:127], v[96:99], v[28:31]
    ds_read_b128 v[96:99], v3 offset:8704
    v_mfma_f32_16x16x32_bf16 v[32:35], v[120:123], v[100:103], v[32:35]
    s_add_u32 s49, s49, 1277952
    v_mfma_f32_16x16x32_bf16 v[36:39], v[124:127], v[100:103], v[36:39]
    ds_read_b128 v[100:103], v10 offset:9728
    s_waitcnt lgkmcnt(4)
    s_waitcnt lgkmcnt(3)
    v_mfma_f32_16x16x32_bf16 v[16:19], v[128:131], v[80:83], v[16:19]
    s_barrier
    v_mfma_f32_16x16x32_bf16 v[20:23], v[132:135], v[80:83], v[20:23]
    ds_read_b128 v[80:83], v3 offset:10240
    ds_read_b128 v[144:147], v4 offset:16384
    v_mfma_f32_16x16x32_bf16 v[24:27], v[128:131], v[84:87], v[24:27]
    ds_read_b128 v[148:151], v4 offset:18432
    v_mfma_f32_16x16x32_bf16 v[28:31], v[132:135], v[84:87], v[28:31]
    ds_read_b128 v[84:87], v3 offset:11264
    ds_read_b128 v[152:155], v5 offset:16384
    v_mfma_f32_16x16x32_bf16 v[32:35], v[128:131], v[88:91], v[32:35]
    ds_read_b128 v[156:159], v5 offset:18432
    v_mfma_f32_16x16x32_bf16 v[36:39], v[132:135], v[88:91], v[36:39]
    ds_read_b128 v[88:91], v10 offset:12288
    s_waitcnt lgkmcnt(7)
    v_mfma_f32_16x16x32_bf16 v[16:19], v[136:139], v[92:95], v[16:19]
    s_mul_i32 s51, s37, 9728
    v_mfma_f32_16x16x32_bf16 v[20:23], v[140:143], v[92:95], v[20:23]
    ds_read_b128 v[92:95], v3 offset:12800
    v_mfma_f32_16x16x32_bf16 v[24:27], v[136:139], v[96:99], v[24:27]
    s_add_u32 s51, s51, 3907584
    v_mfma_f32_16x16x32_bf16 v[28:31], v[140:143], v[96:99], v[28:31]
    ds_read_b128 v[96:99], v3 offset:13824
    v_mfma_f32_16x16x32_bf16 v[32:35], v[136:139], v[100:103], v[32:35]
    s_add_u32 s52, s51, 4096
    v_mfma_f32_16x16x32_bf16 v[36:39], v[140:143], v[100:103], v[36:39]
    ds_read_b128 v[100:103], v10 offset:14848
    s_waitcnt lgkmcnt(4)
    s_waitcnt lgkmcnt(3)
    v_mfma_f32_16x16x32_bf16 v[16:19], v[144:147], v[80:83], v[16:19]
    s_barrier
    v_mfma_f32_16x16x32_bf16 v[20:23], v[148:151], v[80:83], v[20:23]
    ds_read_b128 v[80:83], v3 offset:15360
    ds_read_b128 v[160:163], v4 offset:32768
    v_mfma_f32_16x16x32_bf16 v[24:27], v[144:147], v[84:87], v[24:27]
    ds_read_b128 v[164:167], v4 offset:34816
    v_mfma_f32_16x16x32_bf16 v[28:31], v[148:151], v[84:87], v[28:31]
    ds_read_b128 v[84:87], v3 offset:16384
    ds_read_b128 v[168:171], v5 offset:32768
    v_mfma_f32_16x16x32_bf16 v[32:35], v[144:147], v[88:91], v[32:35]
    ds_read_b128 v[172:175], v5 offset:34816
    v_mfma_f32_16x16x32_bf16 v[36:39], v[148:151], v[88:91], v[36:39]
    ds_read_b128 v[88:91], v10 offset:17408
    s_waitcnt lgkmcnt(7)
    v_mfma_f32_16x16x32_bf16 v[16:19], v[152:155], v[92:95], v[16:19]
    s_add_u32 s53, s51, 8192
    v_mfma_f32_16x16x32_bf16 v[20:23], v[156:159], v[92:95], v[20:23]
    ds_read_b128 v[92:95], v3 offset:17920
    v_mfma_f32_16x16x32_bf16 v[24:27], v[152:155], v[96:99], v[24:27]
    s_mul_i32 s92, s34, 55296
    v_mfma_f32_16x16x32_bf16 v[28:31], v[156:159], v[96:99], v[28:31]
    ds_read_b128 v[96:99], v3 offset:18944
    v_mfma_f32_16x16x32_bf16 v[32:35], v[152:155], v[100:103], v[32:35]
    s_add_u32 s92, s92, 393216
    v_mfma_f32_16x16x32_bf16 v[36:39], v[156:159], v[100:103], v[36:39]
    ds_read_b128 v[100:103], v10 offset:19968
    s_waitcnt lgkmcnt(4)
    s_waitcnt lgkmcnt(3)
    v_mfma_f32_16x16x32_bf16 v[16:19], v[160:163], v[80:83], v[16:19]
    s_barrier
    v_mfma_f32_16x16x32_bf16 v[20:23], v[164:167], v[80:83], v[20:23]
    ds_read_b128 v[80:83], v3 offset:20480
    ds_read_b128 v[176:179], v4 offset:49152
    v_mfma_f32_16x16x32_bf16 v[24:27], v[160:163], v[84:87], v[24:27]
    ds_read_b128 v[180:183], v4 offset:51200
    v_mfma_f32_16x16x32_bf16 v[28:31], v[164:167], v[84:87], v[28:31]
    ds_read_b128 v[84:87], v3 offset:21504
    ds_read_b128 v[184:187], v5 offset:49152
    v_mfma_f32_16x16x32_bf16 v[32:35], v[160:163], v[88:91], v[32:35]
    ds_read_b128 v[188:191], v5 offset:51200
    v_mfma_f32_16x16x32_bf16 v[36:39], v[164:167], v[88:91], v[36:39]
    ds_read_b128 v[88:91], v10 offset:22528
    s_waitcnt lgkmcnt(7)
    v_mfma_f32_16x16x32_bf16 v[16:19], v[168:171], v[92:95], v[16:19]
    s_sub_u32 s38, s35, 1
    s_cselect_b32 s38, 8, s38
    v_mfma_f32_16x16x32_bf16 v[20:23], v[172:175], v[92:95], v[20:23]
    ds_read_b128 v[92:95], v3 offset:0
    v_mfma_f32_16x16x32_bf16 v[24:27], v[168:171], v[96:99], v[24:27]
    s_mul_i32 s38, s38, 6144
    v_mfma_f32_16x16x32_bf16 v[28:31], v[172:175], v[96:99], v[28:31]
    ds_read_b128 v[96:99], v3 offset:1024
    v_mfma_f32_16x16x32_bf16 v[32:35], v[168:171], v[100:103], v[32:35]
    s_mul_i32 s94, s32, 1536
    v_mfma_f32_16x16x32_bf16 v[36:39], v[172:175], v[100:103], v[36:39]
    ds_read_b128 v[100:103], v10 offset:2048
    s_waitcnt lgkmcnt(4)
    s_waitcnt lgkmcnt(3)
    v_mfma_f32_16x16x32_bf16 v[16:19], v[176:179], v[80:83], v[16:19]
    s_barrier
    v_mfma_f32_16x16x32_bf16 v[20:23], v[180:183], v[80:83], v[20:23]
    ds_read_b128 v[80:83], v3 offset:2560
    ds_read_b128 v[192:195], v4 offset:0
    v_mfma_f32_16x16x32_bf16 v[24:27], v[176:179], v[84:87], v[24:27]
    ds_read_b128 v[196:199], v4 offset:2048
    v_mfma_f32_16x16x32_bf16 v[28:31], v[180:183], v[84:87], v[28:31]
    ds_read_b128 v[84:87], v3 offset:3584
    ds_read_b128 v[200:203], v5 offset:0
    v_mfma_f32_16x16x32_bf16 v[32:35], v[176:179], v[88:91], v[32:35]
    ds_read_b128 v[204:207], v5 offset:2048
    v_mfma_f32_16x16x32_bf16 v[36:39], v[180:183], v[88:91], v[36:39]
    ds_read_b128 v[88:91], v10 offset:4608
    s_waitcnt lgkmcnt(7)
    v_mul_f32 v16, v110, v16
    v_mul_f32 v17, v110, v17
    v_mul_f32 v18, v110, v18
    v_mul_f32 v19, v110, v19
    s_nop 1
    v_mfma_f32_16x16x32_bf16 v[16:19], v[184:187], v[92:95], v[16:19]
    s_add_u32 s38, s38, s94
    v_mul_f32 v20, v110, v20
    v_mul_f32 v21, v110, v21
    v_mul_f32 v22, v110, v22
    v_mul_f32 v23, v110, v23
    s_nop 1
    v_mfma_f32_16x16x32_bf16 v[20:23], v[188:191], v[92:95], v[20:23]
    ds_read_b128 v[92:95], v3 offset:5120
    v_mul_f32 v24, v110, v24
    v_mul_f32 v25, v110, v25
    v_mul_f32 v26, v110, v26
    v_mul_f32 v27, v110, v27
    s_nop 1
    v_mfma_f32_16x16x32_bf16 v[24:27], v[184:187], v[96:99], v[24:27]
    s_add_u32 s93, s38, s92
    v_mul_f32 v28, v110, v28
    v_mul_f32 v29, v110, v29
    v_mul_f32 v30, v110, v30
    v_mul_f32 v31, v110, v31
    s_nop 1
    v_mfma_f32_16x16x32_bf16 v[28:31], v[188:191], v[96:99], v[28:31]
    ds_read_b128 v[96:99], v3 offset:6144
    v_mul_f32 v32, v110, v32
    v_mul_f32 v33, v110, v33
    v_mul_f32 v34, v110, v34
    v_mul_f32 v35, v110, v35
    s_nop 1
    v_mfma_f32_16x16x32_bf16 v[32:35], v[184:187], v[100:103], v[32:35]
    s_lshl1_add_u32 s38, s35, s32
    v_mul_f32 v36, v110, v36
    v_mul_f32 v37, v110, v37
    v_mul_f32 v38, v110, v38
    v_mul_f32 v39, v110, v39
    s_nop 1
    v_mfma_f32_16x16x32_bf16 v[36:39], v[188:191], v[100:103], v[36:39]
    ds_read_b128 v[100:103], v10 offset:7168
    s_waitcnt lgkmcnt(4)
    s_waitcnt lgkmcnt(3)
    v_mfma_f32_16x16x32_bf16 v[16:19], v[192:195], v[80:83], v[16:19]
    s_barrier
    v_mfma_f32_16x16x32_bf16 v[20:23], v[196:199], v[80:83], v[20:23]
    ds_read_b128 v[80:83], v3 offset:7680
    ds_read_b128 v[208:211], v4 offset:16384
    v_mfma_f32_16x16x32_bf16 v[24:27], v[192:195], v[84:87], v[24:27]
    ds_read_b128 v[212:215], v4 offset:18432
    v_mfma_f32_16x16x32_bf16 v[28:31], v[196:199], v[84:87], v[28:31]
    ds_read_b128 v[84:87], v3 offset:8704
    ds_read_b128 v[216:219], v5 offset:16384
    v_mfma_f32_16x16x32_bf16 v[32:35], v[192:195], v[88:91], v[32:35]
    ds_read_b128 v[220:223], v5 offset:18432
    v_mfma_f32_16x16x32_bf16 v[36:39], v[196:199], v[88:91], v[36:39]
    ds_read_b128 v[88:91], v10 offset:9728
    s_waitcnt lgkmcnt(7)
    v_mfma_f32_16x16x32_bf16 v[16:19], v[200:203], v[92:95], v[16:19]
    s_sub_u32 s39, s38, 6
    s_cselect_b32 s38, 18, 0
    v_mfma_f32_16x16x32_bf16 v[20:23], v[204:207], v[92:95], v[20:23]
    ds_read_b128 v[92:95], v3 offset:10240
    v_mfma_f32_16x16x32_bf16 v[24:27], v[200:203], v[96:99], v[24:27]
    s_add_u32 s38, s38, s39
    v_mfma_f32_16x16x32_bf16 v[28:31], v[204:207], v[96:99], v[28:31]
    ds_read_b128 v[96:99], v3 offset:11264
    v_mfma_f32_16x16x32_bf16 v[32:35], v[200:203], v[100:103], v[32:35]
    s_mul_i32 s38, s38, 3072
    v_mfma_f32_16x16x32_bf16 v[36:39], v[204:207], v[100:103], v[36:39]
    ds_read_b128 v[100:103], v10 offset:12288
    s_waitcnt lgkmcnt(4)
    s_waitcnt lgkmcnt(3)
    v_mfma_f32_16x16x32_bf16 v[16:19], v[208:211], v[80:83], v[16:19]
    s_barrier
    v_mfma_f32_16x16x32_bf16 v[20:23], v[212:215], v[80:83], v[20:23]
    ds_read_b128 v[80:83], v3 offset:12800
    ds_read_b128 v[224:227], v4 offset:32768
    v_mfma_f32_16x16x32_bf16 v[24:27], v[208:211], v[84:87], v[24:27]
    ds_read_b128 v[228:231], v4 offset:34816
    v_mfma_f32_16x16x32_bf16 v[28:31], v[212:215], v[84:87], v[28:31]
    ds_read_b128 v[84:87], v3 offset:13824
    ds_read_b128 v[232:235], v5 offset:32768
    v_mfma_f32_16x16x32_bf16 v[32:35], v[208:211], v[88:91], v[32:35]
    ds_read_b128 v[236:239], v5 offset:34816
    v_mfma_f32_16x16x32_bf16 v[36:39], v[212:215], v[88:91], v[36:39]
    ds_read_b128 v[88:91], v10 offset:14848
    s_waitcnt lgkmcnt(7)
    v_mfma_f32_16x16x32_bf16 v[16:19], v[216:219], v[92:95], v[16:19]
    s_add_u32 s92, s92, s38
    v_mfma_f32_16x16x32_bf16 v[20:23], v[220:223], v[92:95], v[20:23]
    ds_read_b128 v[92:95], v3 offset:15360
    v_mfma_f32_16x16x32_bf16 v[24:27], v[216:219], v[96:99], v[24:27]
    v_mfma_f32_16x16x32_bf16 v[28:31], v[220:223], v[96:99], v[28:31]
    ds_read_b128 v[96:99], v3 offset:16384
    v_mfma_f32_16x16x32_bf16 v[32:35], v[216:219], v[100:103], v[32:35]
    v_mfma_f32_16x16x32_bf16 v[36:39], v[220:223], v[100:103], v[36:39]
    ds_read_b128 v[100:103], v10 offset:17408
    s_waitcnt lgkmcnt(4)
    s_waitcnt lgkmcnt(3)
    v_mfma_f32_16x16x32_bf16 v[16:19], v[224:227], v[80:83], v[16:19]
    v_mfma_f32_16x16x32_bf16 v[20:23], v[228:231], v[80:83], v[20:23]
    ds_read_b128 v[80:83], v3 offset:17920
    v_mfma_f32_16x16x32_bf16 v[24:27], v[224:227], v[84:87], v[24:27]
    v_mfma_f32_16x16x32_bf16 v[28:31], v[228:231], v[84:87], v[28:31]
    ds_read_b128 v[84:87], v3 offset:18944
    v_mfma_f32_16x16x32_bf16 v[32:35], v[224:227], v[88:91], v[32:35]
    v_mfma_f32_16x16x32_bf16 v[36:39], v[228:231], v[88:91], v[36:39]
    ds_read_b128 v[88:91], v10 offset:19968
    s_barrier
    s_waitcnt lgkmcnt(3)
    v_mfma_f32_16x16x32_bf16 v[16:19], v[232:235], v[92:95], v[16:19]
    ds_read_b128 v[240:243], v4 offset:49152
    v_mfma_f32_16x16x32_bf16 v[20:23], v[236:239], v[92:95], v[20:23]
    ds_read_b128 v[92:95], v3 offset:20480
    ds_read_b128 v[244:247], v4 offset:51200
    v_mfma_f32_16x16x32_bf16 v[24:27], v[232:235], v[96:99], v[24:27]
    ds_read_b128 v[248:251], v5 offset:49152
    v_mfma_f32_16x16x32_bf16 v[28:31], v[236:239], v[96:99], v[28:31]
    ds_read_b128 v[96:99], v3 offset:21504
    ds_read_b128 v[252:255], v5 offset:51200
    v_mfma_f32_16x16x32_bf16 v[32:35], v[232:235], v[100:103], v[32:35]
    v_mfma_f32_16x16x32_bf16 v[36:39], v[236:239], v[100:103], v[36:39]
    ds_read_b128 v[100:103], v10 offset:22528
    s_waitcnt lgkmcnt(1)
    v_mfma_f32_16x16x32_bf16 v[16:19], v[240:243], v[80:83], v[16:19]
    v_mfma_f32_16x16x32_bf16 v[20:23], v[244:247], v[80:83], v[20:23]
    ds_read_b128 v[80:83], v3 offset:23040
    v_mfma_f32_16x16x32_bf16 v[24:27], v[240:243], v[84:87], v[24:27]
    v_mfma_f32_16x16x32_bf16 v[28:31], v[244:247], v[84:87], v[28:31]
    ds_read_b128 v[84:87], v3 offset:24064
    v_mfma_f32_16x16x32_bf16 v[32:35], v[240:243], v[88:91], v[32:35]
    v_mfma_f32_16x16x32_bf16 v[36:39], v[244:247], v[88:91], v[36:39]
    ds_read_b128 v[88:91], v3 offset:25088
    s_waitcnt lgkmcnt(3)
    v_mfma_f32_16x16x32_bf16 v[16:19], v[248:251], v[92:95], v[16:19]
    v_mfma_f32_16x16x32_bf16 v[20:23], v[252:255], v[92:95], v[20:23]
    ds_read_b128 v[92:95], v3 offset:26112
    v_mfma_f32_16x16x32_bf16 v[24:27], v[248:251], v[96:99], v[24:27]
    v_mfma_f32_16x16x32_bf16 v[28:31], v[252:255], v[96:99], v[28:31]
    ds_read_b128 v[96:99], v3 offset:27136
    v_mfma_f32_16x16x32_bf16 v[32:35], v[248:251], v[100:103], v[32:35]
    v_mfma_f32_16x16x32_bf16 v[36:39], v[252:255], v[100:103], v[36:39]
    ds_read_b128 v[100:103], v3 offset:28160
    v_cvt_pk_bf16_f32 v16, v16, v17
    v_cvt_pk_bf16_f32 v17, v18, v19
    v_cvt_pk_bf16_f32 v18, v20, v21
    v_cvt_pk_bf16_f32 v19, v22, v23
    v_cvt_pk_bf16_f32 v20, v24, v25
    v_cvt_pk_bf16_f32 v21, v26, v27
    v_cvt_pk_bf16_f32 v22, v28, v29
    v_cvt_pk_bf16_f32 v23, v30, v31
    v_cvt_pk_bf16_f32 v24, v32, v33
    v_cvt_pk_bf16_f32 v25, v34, v35
    v_cvt_pk_bf16_f32 v26, v36, v37
    v_cvt_pk_bf16_f32 v27, v38, v39
    v_mov_b32_dpp v28, v24 row_ror:8 row_mask:0xf bank_mask:0xf
    v_mov_b32_dpp v29, v25 row_ror:8 row_mask:0xf bank_mask:0xf
    v_mov_b32_dpp v30, v26 row_ror:8 row_mask:0xf bank_mask:0xf
    v_mov_b32_dpp v31, v27 row_ror:8 row_mask:0xf bank_mask:0xf
    s_waitcnt lgkmcnt(5)
    v_mfma_f32_16x16x32_bf16 v[32:35], v[80:83], v[16:19], 0
    v_mfma_f32_16x16x32_bf16 v[36:39], v[80:83], v[24:27], 0
    ds_read_b128 v[80:83], v3 offset:29184
    s_waitcnt lgkmcnt(5)
    v_mfma_f32_16x16x32_bf16 v[32:35], v[84:87], v[20:23], v[32:35]
    v_mfma_f32_16x16x32_bf16 v[36:39], v[84:87], v[28:31], v[36:39]
    ds_read_b128 v[84:87], v3 offset:30208
    s_waitcnt lgkmcnt(5)
    v_mfma_f32_16x16x32_bf16 v[72:75], v[88:91], v[16:19], 0
    v_mfma_f32_16x16x32_bf16 v[76:79], v[88:91], v[24:27], 0
    s_waitcnt lgkmcnt(4)
    v_mfma_f32_16x16x32_bf16 v[72:75], v[92:95], v[20:23], v[72:75]
    v_mfma_f32_16x16x32_bf16 v[76:79], v[92:95], v[28:31], v[76:79]
    v_cvt_pk_bf16_f32 v32, v32, v33
    ds_write_b32 v111, v32 offset:0
    v_cvt_pk_bf16_f32 v34, v34, v35
    ds_write_b32 v111, v34 offset:304
    s_mov_b32 exec_lo, 0x70007
    s_mov_b32 exec_hi, 0x70007
    v_cvt_pk_bf16_f32 v36, v36, v37
    ds_write_b32 v111, v36 offset:256
    v_cvt_pk_bf16_f32 v38, v38, v39
    ds_write_b32 v111, v38 offset:560
    s_mov_b64 exec, -1
    s_waitcnt lgkmcnt(7)
    v_mfma_f32_16x16x32_bf16 v[88:91], v[96:99], v[16:19], 0
    v_mfma_f32_16x16x32_bf16 v[92:95], v[96:99], v[24:27], 0
    s_waitcnt lgkmcnt(6)
    v_mfma_f32_16x16x32_bf16 v[88:91], v[100:103], v[20:23], v[88:91]
    v_mfma_f32_16x16x32_bf16 v[92:95], v[100:103], v[28:31], v[92:95]
    v_cvt_pk_bf16_f32 v72, v72, v73
    ds_write_b32 v111, v72 offset:2432
    v_cvt_pk_bf16_f32 v74, v74, v75
    ds_write_b32 v111, v74 offset:2736
    s_mov_b32 exec_lo, 0x70007
    s_mov_b32 exec_hi, 0x70007
    v_cvt_pk_bf16_f32 v76, v76, v77
    ds_write_b32 v111, v76 offset:2688
    v_cvt_pk_bf16_f32 v78, v78, v79
    ds_write_b32 v111, v78 offset:2992
    s_mov_b64 exec, -1
    s_waitcnt lgkmcnt(9)
    v_mfma_f32_16x16x32_bf16 v[96:99], v[80:83], v[16:19], 0
    v_mfma_f32_16x16x32_bf16 v[100:103], v[80:83], v[24:27], 0
    s_waitcnt lgkmcnt(8)
    v_mfma_f32_16x16x32_bf16 v[96:99], v[84:87], v[20:23], v[96:99]
    v_mfma_f32_16x16x32_bf16 v[100:103], v[84:87], v[28:31], v[100:103]
    v_cvt_pk_bf16_f32 v88, v88, v89
    ds_write_b32 v111, v88 offset:4864
    v_cvt_pk_bf16_f32 v90, v90, v91
    ds_write_b32 v111, v90 offset:5168
    s_mov_b32 exec_lo, 0x70007
    s_mov_b32 exec_hi, 0x70007
    v_cvt_pk_bf16_f32 v92, v92, v93
    ds_write_b32 v111, v92 offset:5120
    v_cvt_pk_bf16_f32 v94, v94, v95
    ds_write_b32 v111, v94 offset:5424
    s_mov_b64 exec, -1
    v_cvt_pk_bf16_f32 v96, v96, v97
    ds_write_b32 v111, v96 offset:7296
    v_cvt_pk_bf16_f32 v98, v98, v99
    ds_write_b32 v111, v98 offset:7600
    s_mov_b32 exec_lo, 0x70007
    s_mov_b32 exec_hi, 0x70007
    v_cvt_pk_bf16_f32 v100, v100, v101
    ds_write_b32 v111, v100 offset:7552
    v_cvt_pk_bf16_f32 v102, v102, v103
    ds_write_b32 v111, v102 offset:7856
    s_mov_b64 exec, -1
    v_add_u32 v4, 40448, v3
    s_waitcnt lgkmcnt(0)
    s_barrier
    ds_read_b128 v[16:19], v7 offset:0
    ds_read_b128 v[20:23], v7 offset:4096
    ds_read_b128 v[24:27], v15 offset:8192
    s_lshl1_add_u32 m0, s94, 133632
    s_nop 0
    buffer_load_dwordx4 v3, s[8:11], s92 offen offset:0 sc1 lds
    buffer_load_dwordx4 v3, s[8:11], s92 offen offset:1024 sc1 lds
    buffer_load_dwordx4 v3, s[8:11], s92 offen offset:2048 sc1 lds
    s_add_u32 m0, s94, 145920
    s_nop 0
    buffer_load_dwordx4 v3, s[8:11], s93 offen offset:0 sc1 lds
    s_mov_b32 exec_hi, 0
    buffer_load_dwordx4 v3, s[8:11], s93 offen offset:1024 sc1 lds
    s_mov_b64 exec, -1
    s_add_u32 s38, s35, s32
    s_add_u32 s38, s38, 0
    s_sub_u32 s39, s38, 9
    s_cselect_b32 s38, s38, s39
    s_lshl_b32 s38, s38, 12
    s_add_u32 m0, s44, 40448
    s_add_u32 s46, s38, s49
    buffer_load_dwordx4 v3, s[8:11], s46 offen offset:0 sc1 lds
    s_cmp_eq_u32 s43, 0
    s_cselect_b32 s59, -1, 0x000f000f
    s_lshl4_add_u32 s56, s34, s33
    s_lshl1_add_u32 s56, s56, s42
    s_mul_i32 s56, s56, 1536
    buffer_load_dwordx4 v3, s[8:11], s46 offen offset:1024 sc1 lds
    s_add_u32 s56, s56, 3121152
    s_lshl_b32 s57, s43, 10
    s_add_u32 s54, s56, s57
    s_lshl_b32 s57, s43, 7
    buffer_load_dwordx4 v3, s[8:11], s46 offen offset:2048 sc1 lds
    s_add_u32 s55, s56, s57
    s_mul_i32 s45, s41, 82944
    s_add_u32 s45, s45, 2457600
    s_lshl_b32 s12, s34, 6
    buffer_load_dwordx4 v3, s[8:11], s46 offen offset:3072 sc1 lds
    s_add_u32 s12, s12, s32
    s_mul_i32 s12, s12, 768
    s_add_u32 s12, s12, 3121152
    s_add_u32 s13, s12, 12288
    s_barrier
    s_waitcnt lgkmcnt(2)
    buffer_store_dwordx4 v[16:19], v6, s[8:11], s51 offen sc1
    s_add_u32 s14, s12, 24576
    s_add_u32 s15, s12, 36864
    s_and_b32 s57, s33, 12
    s_add_u32 s57, s57, s33
    s_waitcnt lgkmcnt(1)
    buffer_store_dwordx4 v[20:23], v6, s[8:11], s52 offen sc1
    s_lshl2_add_u32 s5, s5, s57
    s_lshr_b32 s56, s40, 1
    s_and_b32 s57, s40, 7
    s_cselect_b32 s56, 1, s56
    s_cmp_ge_u32 s41, 4
    s_cselect_b32 s56, s56, 0
    s_cselect_b32 s16, 16, 0
    s_waitcnt lgkmcnt(0)
    buffer_store_dwordx4 v[24:27], v11, s[8:11], s53 offen sc1
    s_xor_b32 s5, s5, s56
    s_mul_i32 s56, s5, 304
    s_add_u32 s16, s16, s56
    s_mul_i32 s56, s32, 622592
    s_add_u32 s38, s35, s32
    s_add_u32 s38, s38, 4
    s_sub_u32 s39, s38, 9
    s_cselect_b32 s38, s38, s39
    s_lshl_b32 s38, s38, 12
    s_add_u32 m0, s44, 56832
    s_add_u32 s46, s38, s49
    buffer_load_dwordx4 v3, s[8:11], s46 offen offset:0 sc1 lds
    s_add_u32 s16, s16, s56
    s_add_u32 s16, s16, 3907584
    s_mul_i32 s17, s32, 4608
    s_add_u32 s17, s17, 40448
    buffer_load_dwordx4 v3, s[8:11], s46 offen offset:1024 sc1 lds
    s_lshr_b32 s56, s4, 4
    s_lshl1_add_u32 s56, s42, s56
    s_lshl2_add_u32 s6, s33, s56
    s_lshl_b32 s6, s6, 7
    buffer_load_dwordx4 v3, s[8:11], s46 offen offset:2048 sc1 lds
    s_add_u32 s6, s6, 77824
    s_lshl1_add_u32 s56, s56, s43
    s_lshl_b32 s57, s56, 6
    s_add_u32 s5, s57, 36864
    s_waitcnt vmcnt(10)
    s_barrier
    buffer_load_dwordx4 v3, s[8:11], s46 offen offset:3072 sc1 lds
    s_lshl3_add_u32 s56, s33, s56
    s_mul_i32 s18, s56, 18432
    s_add_u32 s18, s18, 6397952
    s_add_u32 s19, s18, 4096
    s_sub_u32 s38, s35, 1
    s_cselect_b32 s38, 8, s38
    s_lshl_b32 s38, s38, 12
    s_add_u32 s38, s38, s48
    s_add_u32 m0, s48, 73216
    s_add_u32 s46, s38, s49
    buffer_load_dwordx4 v3, s[8:11], s46 offen offset:0 sc1 lds
    s_add_u32 s20, s18, 8192
    s_add_u32 s21, s18, 12288
    s_add_u32 s22, s18, 16384
    s_mul_i32 s23, s27, 1152
    s_add_u32 s38, s35, s32
    s_add_u32 s38, s38, 0
    s_sub_u32 s39, s38, 9
    s_cselect_b32 s38, s38, s39
    s_lshl_b32 s38, s38, 12
    s_add_u32 m0, s44, 0
    s_add_u32 s46, s38, s50
    buffer_load_dwordx4 v3, s[8:11], s46 offen offset:0 sc1 lds
    s_add_u32 s24, s23, 73728
    s_add_u32 s25, s23, 147456
    s_add_u32 s26, s23, 221184
    s_lshl2_add_u32 s56, s33, s32
    buffer_load_dwordx4 v3, s[8:11], s46 offen offset:1024 sc1 lds
    s_mul_i32 s56, s56, 36864
    s_add_u32 s56, s56, 6397952
    s_lshl_b32 s57, s34, 10
    s_add_u32 s88, s56, s57
    buffer_load_dwordx4 v3, s[8:11], s46 offen offset:2048 sc1 lds
    s_add_u32 s89, s88, 18432
    s_lshl_b32 s57, s34, 7
    s_add_u32 s90, s56, s57
    s_add_u32 s90, s90, 16384
    buffer_load_dwordx4 v3, s[8:11], s46 offen offset:3072 sc1 lds
    s_lshl_b32 s95, s37, 7
    s_add_u32 s95, s95, 32768
    s_lshl2_add_u32 s91, s34, s32
    s_lshl_b32 s91, s91, 7
    s_add_u32 s38, s35, s32
    s_add_u32 s38, s38, 4
    s_sub_u32 s39, s38, 9
    s_cselect_b32 s38, s38, s39
    s_lshl_b32 s38, s38, 12
    s_add_u32 m0, s44, 16384
    s_add_u32 s46, s38, s50
    buffer_load_dwordx4 v3, s[8:11], s46 offen offset:0 sc1 lds
    s_add_u32 s91, s91, 69632
    buffer_load_dwordx4 v3, s[8:11], s46 offen offset:1024 sc1 lds
    buffer_load_dwordx4 v3, s[8:11], s46 offen offset:2048 sc1 lds
    buffer_load_dwordx4 v3, s[8:11], s46 offen offset:3072 sc1 lds
    s_sub_u32 s38, s35, 1
    s_cselect_b32 s38, 8, s38
    s_lshl_b32 s38, s38, 12
    s_add_u32 s38, s38, s48
    s_add_u32 m0, s48, 32768
    s_add_u32 s46, s38, s50
    buffer_load_dwordx4 v3, s[8:11], s46 offen offset:0 sc1 lds
    v_mov_b32 v32, -1
    v_mov_b32 v33, -1
    v_mov_b32 v34, -1
    v_mov_b32 v35, -1
    s_waitcnt vmcnt(9)
    s_barrier
    s_cmp_lg_u32 s32, 0
    s_cbranch_scc1 L_N_nfz
    s_mov_b32 s94, s36
    s_atomic_swap s94, s[8:9], s95 glc
L_N_nfz:
    ds_read_b128 v[80:83], v4 offset:0
    ds_read_b128 v[84:87], v4 offset:1024
    ds_read_b128 v[88:91], v4 offset:2048
    ds_read_b128 v[92:95], v4 offset:3072
    s_waitcnt lgkmcnt(2)
    v_mfma_f32_16x16x32_bf16 v[16:19], v[80:83], v[112:115], 0
    ds_read_b128 v[96:99], v4 offset:4096
    v_mfma_f32_16x16x32_bf16 v[20:23], v[80:83], v[116:119], 0
    s_mul_i32 s38, s33, 3072
    s_add_u32 s38, s38, s12
    s_mov_b32 exec_hi, 0xffff
    buffer_store_dwordx4 v[32:35], v3, s[8:11], s38 offen sc1
    s_mov_b32 exec_hi, -1
    v_mfma_f32_16x16x32_bf16 v[24:27], v[84:87], v[112:115], 0
    ds_read_b128 v[100:103], v4 offset:5120
    v_mfma_f32_16x16x32_bf16 v[28:31], v[84:87], v[116:119], 0
    s_waitcnt lgkmcnt(2)
    v_mfma_f32_16x16x32_bf16 v[16:19], v[88:91], v[120:123], v[16:19]
    ds_read_b128 v[80:83], v4 offset:6144
    v_mfma_f32_16x16x32_bf16 v[20:23], v[88:91], v[124:127], v[20:23]
    s_mul_i32 s39, s32, 9216
    s_add_u32 m0, s39, 86528
    s_add_u32 s46, s39, 27648
    s_add_u32 s46, s46, s45
    buffer_load_dwordx4 v3, s[8:11], s46 offen offset:0 sc1 lds
    v_mfma_f32_16x16x32_bf16 v[24:27], v[92:95], v[120:123], v[24:27]
    ds_read_b128 v[84:87], v4 offset:7168
    v_mfma_f32_16x16x32_bf16 v[28:31], v[92:95], v[124:127], v[28:31]
    s_waitcnt lgkmcnt(2)
    v_mfma_f32_16x16x32_bf16 v[16:19], v[96:99], v[128:131], v[16:19]
    ds_read_b128 v[88:91], v4 offset:8192
    v_mfma_f32_16x16x32_bf16 v[20:23], v[96:99], v[132:135], v[20:23]
    buffer_load_dwordx4 v3, s[8:11], s46 offen offset:1024 sc1 lds
    v_mfma_f32_16x16x32_bf16 v[24:27], v[100:103], v[128:131], v[24:27]
    ds_read_b128 v[92:95], v4 offset:9216
    v_mfma_f32_16x16x32_bf16 v[28:31], v[100:103], v[132:135], v[28:31]
    s_waitcnt lgkmcnt(2)
    v_mfma_f32_16x16x32_bf16 v[16:19], v[80:83], v[136:139], v[16:19]
    ds_read_b128 v[96:99], v4 offset:10240
    v_mfma_f32_16x16x32_bf16 v[20:23], v[80:83], v[140:143], v[20:23]
    buffer_load_dwordx4 v3, s[8:11], s46 offen offset:2048 sc1 lds
    v_mfma_f32_16x16x32_bf16 v[24:27], v[84:87], v[136:139], v[24:27]
    ds_read_b128 v[100:103], v4 offset:11264
    v_mfma_f32_16x16x32_bf16 v[28:31], v[84:87], v[140:143], v[28:31]
    s_waitcnt lgkmcnt(2)
    v_mfma_f32_16x16x32_bf16 v[16:19], v[88:91], v[144:147], v[16:19]
    ds_read_b128 v[80:83], v4 offset:12288
    v_mfma_f32_16x16x32_bf16 v[20:23], v[88:91], v[148:151], v[20:23]
    buffer_load_dwordx4 v3, s[8:11], s46 offen offset:3072 sc1 lds
    v_mfma_f32_16x16x32_bf16 v[24:27], v[92:95], v[144:147], v[24:27]
    ds_read_b128 v[84:87], v4 offset:13312
    v_mfma_f32_16x16x32_bf16 v[28:31], v[92:95], v[148:151], v[28:31]
    s_waitcnt lgkmcnt(2)
    v_mfma_f32_16x16x32_bf16 v[16:19], v[96:99], v[152:155], v[16:19]
    ds_read_b128 v[88:91], v4 offset:14336
    v_mfma_f32_16x16x32_bf16 v[20:23], v[96:99], v[156:159], v[20:23]
    s_mul_i32 s39, s32, 9216
    s_add_u32 m0, s39, 90624
    s_add_u32 s46, s39, 31744
    s_add_u32 s46, s46, s45
    buffer_load_dwordx4 v3, s[8:11], s46 offen offset:0 sc1 lds
    v_mfma_f32_16x16x32_bf16 v[24:27], v[100:103], v[152:155], v[24:27]
    ds_read_b128 v[92:95], v4 offset:15360
    v_mfma_f32_16x16x32_bf16 v[28:31], v[100:103], v[156:159], v[28:31]
    s_waitcnt lgkmcnt(2)
    v_mfma_f32_16x16x32_bf16 v[16:19], v[80:83], v[160:163], v[16:19]
    ds_read_b128 v[96:99], v4 offset:16384
    v_mfma_f32_16x16x32_bf16 v[20:23], v[80:83], v[164:167], v[20:23]
    buffer_load_dwordx4 v3, s[8:11], s46 offen offset:1024 sc1 lds
    v_mfma_f32_16x16x32_bf16 v[24:27], v[84:87], v[160:163], v[24:27]
    ds_read_b128 v[100:103], v4 offset:17408
    v_mfma_f32_16x16x32_bf16 v[28:31], v[84:87], v[164:167], v[28:31]
    s_waitcnt lgkmcnt(2)
    v_mfma_f32_16x16x32_bf16 v[16:19], v[88:91], v[168:171], v[16:19]
    ds_read_b128 v[80:83], v4 offset:18432
    v_mfma_f32_16x16x32_bf16 v[20:23], v[88:91], v[172:175], v[20:23]
    buffer_load_dwordx4 v3, s[8:11], s46 offen offset:2048 sc1 lds
    v_mfma_f32_16x16x32_bf16 v[24:27], v[92:95], v[168:171], v[24:27]
    ds_read_b128 v[84:87], v4 offset:19456
    v_mfma_f32_16x16x32_bf16 v[28:31], v[92:95], v[172:175], v[28:31]
    s_waitcnt lgkmcnt(2)
    v_mfma_f32_16x16x32_bf16 v[16:19], v[96:99], v[176:179], v[16:19]
    ds_read_b128 v[88:91], v4 offset:20480
    v_mfma_f32_16x16x32_bf16 v[20:23], v[96:99], v[180:183], v[20:23]
    buffer_load_dwordx4 v3, s[8:11], s46 offen offset:3072 sc1 lds
    v_mfma_f32_16x16x32_bf16 v[24:27], v[100:103], v[176:179], v[24:27]
    ds_read_b128 v[92:95], v4 offset:21504
    v_mfma_f32_16x16x32_bf16 v[28:31], v[100:103], v[180:183], v[28:31]
    s_waitcnt lgkmcnt(2)
    v_mfma_f32_16x16x32_bf16 v[16:19], v[80:83], v[184:187], v[16:19]
    ds_read_b128 v[96:99], v4 offset:22528
    v_mfma_f32_16x16x32_bf16 v[20:23], v[80:83], v[188:191], v[20:23]
    s_mul_i32 s39, s32, 9216
    s_add_u32 m0, s39, 94720
    s_add_u32 s46, s39, 35840
    s_add_u32 s46, s46, s45
    buffer_load_dwordx4 v3, s[8:11], s46 offen offset:0 sc1 lds
    v_mfma_f32_16x16x32_bf16 v[24:27], v[84:87], v[184:187], v[24:27]
    ds_read_b128 v[100:103], v4 offset:23552
    v_mfma_f32_16x16x32_bf16 v[28:31], v[84:87], v[188:191], v[28:31]
    s_waitcnt lgkmcnt(2)
    v_mfma_f32_16x16x32_bf16 v[16:19], v[88:91], v[192:195], v[16:19]
    ds_read_b128 v[80:83], v4 offset:24576
    v_mfma_f32_16x16x32_bf16 v[20:23], v[88:91], v[196:199], v[20:23]
    buffer_store_dwordx4 v[32:35], v3, s[8:11], s88 offen sc1
    v_mfma_f32_16x16x32_bf16 v[24:27], v[92:95], v[192:195], v[24:27]
    ds_read_b128 v[84:87], v4 offset:25600
    v_mfma_f32_16x16x32_bf16 v[28:31], v[92:95], v[196:199], v[28:31]
    s_waitcnt lgkmcnt(2)
    v_mfma_f32_16x16x32_bf16 v[16:19], v[96:99], v[200:203], v[16:19]
    ds_read_b128 v[88:91], v4 offset:26624
    v_mfma_f32_16x16x32_bf16 v[20:23], v[96:99], v[204:207], v[20:23]
    buffer_store_dwordx4 v[32:35], v3, s[8:11], s89 offen sc1
    v_mfma_f32_16x16x32_bf16 v[24:27], v[100:103], v[200:203], v[24:27]
    ds_read_b128 v[92:95], v4 offset:27648
    v_mfma_f32_16x16x32_bf16 v[28:31], v[100:103], v[204:207], v[28:31]
    s_waitcnt lgkmcnt(2)
    v_mfma_f32_16x16x32_bf16 v[16:19], v[80:83], v[208:211], v[16:19]
    ds_read_b128 v[96:99], v4 offset:28672
    v_mfma_f32_16x16x32_bf16 v[20:23], v[80:83], v[212:215], v[20:23]
    buffer_store_dword v32, v12, s[8:11], s90 offen sc1
    v_mfma_f32_16x16x32_bf16 v[24:27], v[84:87], v[208:211], v[24:27]
    ds_read_b128 v[100:103], v4 offset:29696
    v_mfma_f32_16x16x32_bf16 v[28:31], v[84:87], v[212:215], v[28:31]
    s_waitcnt lgkmcnt(2)
    v_mfma_f32_16x16x32_bf16 v[16:19], v[88:91], v[216:219], v[16:19]
    ds_read_b128 v[80:83], v4 offset:30720
    v_mfma_f32_16x16x32_bf16 v[20:23], v[88:91], v[220:223], v[20:23]
    v_mfma_f32_16x16x32_bf16 v[24:27], v[92:95], v[216:219], v[24:27]
    ds_read_b128 v[84:87], v4 offset:31744
    v_mfma_f32_16x16x32_bf16 v[28:31], v[92:95], v[220:223], v[28:31]
    s_waitcnt lgkmcnt(2)
    v_mfma_f32_16x16x32_bf16 v[16:19], v[96:99], v[224:227], v[16:19]
    ds_read_b128 v[88:91], v4 offset:32768
    v_mfma_f32_16x16x32_bf16 v[20:23], v[96:99], v[228:231], v[20:23]
    v_mfma_f32_16x16x32_bf16 v[24:27], v[100:103], v[224:227], v[24:27]
    ds_read_b128 v[92:95], v4 offset:33792
    v_mfma_f32_16x16x32_bf16 v[28:31], v[100:103], v[228:231], v[28:31]
    s_waitcnt lgkmcnt(2)
    v_mfma_f32_16x16x32_bf16 v[16:19], v[80:83], v[232:235], v[16:19]
    ds_read_b128 v[96:99], v4 offset:34816
    v_mfma_f32_16x16x32_bf16 v[20:23], v[80:83], v[236:239], v[20:23]
    v_mfma_f32_16x16x32_bf16 v[24:27], v[84:87], v[232:235], v[24:27]
    ds_read_b128 v[100:103], v4 offset:35840
    v_mfma_f32_16x16x32_bf16 v[28:31], v[84:87], v[236:239], v[28:31]
    s_waitcnt lgkmcnt(2)
    v_mfma_f32_16x16x32_bf16 v[16:19], v[88:91], v[240:243], v[16:19]
    v_mfma_f32_16x16x32_bf16 v[20:23], v[88:91], v[244:247], v[20:23]
    v_mfma_f32_16x16x32_bf16 v[24:27], v[92:95], v[240:243], v[24:27]
    v_mfma_f32_16x16x32_bf16 v[28:31], v[92:95], v[244:247], v[28:31]
    s_waitcnt lgkmcnt(0)
    v_mfma_f32_16x16x32_bf16 v[16:19], v[96:99], v[248:251], v[16:19]
    v_mfma_f32_16x16x32_bf16 v[20:23], v[96:99], v[252:255], v[20:23]
    v_mfma_f32_16x16x32_bf16 v[24:27], v[100:103], v[248:251], v[24:27]
    v_mfma_f32_16x16x32_bf16 v[28:31], v[100:103], v[252:255], v[28:31]
    s_setprio 1
    s_nop 3
    v_cvt_pk_bf16_f32 v32, v16, v17
    v_cvt_pk_bf16_f32 v33, v18, v19
    v_cvt_pk_bf16_f32 v34, v24, v25
    v_cvt_pk_bf16_f32 v35, v26, v27
    ds_write_b128 v104, v[32:35] offset:0
    v_cvt_pk_bf16_f32 v36, v20, v21
    v_cvt_pk_bf16_f32 v37, v22, v23
    v_cvt_pk_bf16_f32 v38, v28, v29
    v_cvt_pk_bf16_f32 v39, v30, v31
    ds_write_b128 v104, v[36:39] offset:1280
    s_waitcnt vmcnt(0)
    s_waitcnt lgkmcnt(0)
    s_barrier
    ds_read_b64_tr_b16 v[112:113], v107 offset:0
    ds_read_b64_tr_b16 v[114:115], v107 offset:80
    ds_read_b64_tr_b16 v[116:117], v105 offset:0
    ds_read_b64_tr_b16 v[118:119], v105 offset:144
    ds_read_b64_tr_b16 v[120:121], v105 offset:32
    ds_read_b64_tr_b16 v[122:123], v105 offset:176
    ds_read_b64_tr_b16 v[124:125], v106 offset:0
    ds_read_b64_tr_b16 v[126:127], v106 offset:144
    ds_read_b64_tr_b16 v[128:129], v107 offset:2560
    ds_read_b64_tr_b16 v[130:131], v107 offset:2640
    ds_read_b64_tr_b16 v[132:133], v105 offset:4608
    ds_read_b64_tr_b16 v[134:135], v105 offset:4752
    ds_read_b64_tr_b16 v[136:137], v105 offset:4640
    ds_read_b64_tr_b16 v[138:139], v105 offset:4784
    ds_read_b64_tr_b16 v[140:141], v106 offset:4608
    ds_read_b64_tr_b16 v[142:143], v106 offset:4752
    s_waitcnt lgkmcnt(8)
    v_mfma_f32_16x16x32_bf16 v[16:19], v[116:119], v[112:115], 0
    v_mfma_f32_16x16x32_bf16 v[20:23], v[120:123], v[112:115], 0
    v_mfma_f32_16x16x32_bf16 v[24:27], v[124:127], v[112:115], 0
    ds_read_b64_tr_b16 v[144:145], v107 offset:5120
    ds_read_b64_tr_b16 v[146:147], v107 offset:5200
    ds_read_b64_tr_b16 v[148:149], v105 offset:9216
    ds_read_b64_tr_b16 v[150:151], v105 offset:9360
    ds_read_b64_tr_b16 v[152:153], v105 offset:9248
    ds_read_b64_tr_b16 v[154:155], v105 offset:9392
    ds_read_b64_tr_b16 v[156:157], v106 offset:9216
    ds_read_b64_tr_b16 v[158:159], v106 offset:9360
    s_waitcnt lgkmcnt(8)
    v_mfma_f32_16x16x32_bf16 v[16:19], v[132:135], v[128:131], v[16:19]
    v_mfma_f32_16x16x32_bf16 v[20:23], v[136:139], v[128:131], v[20:23]
    v_mfma_f32_16x16x32_bf16 v[24:27], v[140:143], v[128:131], v[24:27]
    ds_read_b64_tr_b16 v[160:161], v107 offset:7680
    ds_read_b64_tr_b16 v[162:163], v107 offset:7760
    ds_read_b64_tr_b16 v[164:165], v105 offset:13824
    ds_read_b64_tr_b16 v[166:167], v105 offset:13968
    ds_read_b64_tr_b16 v[168:169], v105 offset:13856
    ds_read_b64_tr_b16 v[170:171], v105 offset:14000
    ds_read_b64_tr_b16 v[172:173], v106 offset:13824
    ds_read_b64_tr_b16 v[174:175], v106 offset:13968
    s_waitcnt lgkmcnt(8)
    v_mfma_f32_16x16x32_bf16 v[16:19], v[148:151], v[144:147], v[16:19]
    v_mfma_f32_16x16x32_bf16 v[20:23], v[152:155], v[144:147], v[20:23]
    v_mfma_f32_16x16x32_bf16 v[24:27], v[156:159], v[144:147], v[24:27]
    s_waitcnt lgkmcnt(0)
    v_mfma_f32_16x16x32_bf16 v[16:19], v[164:167], v[160:163], v[16:19]
    v_mfma_f32_16x16x32_bf16 v[20:23], v[168:171], v[160:163], v[20:23]
    v_mfma_f32_16x16x32_bf16 v[24:27], v[172:175], v[160:163], v[24:27]
    s_nop 5
    v_cvt_pk_bf16_f32 v28, v16, v17
    v_cvt_pk_bf16_f32 v29, v18, v19
    v_cvt_pk_bf16_f32 v30, v20, v21
    v_cvt_pk_bf16_f32 v31, v22, v23
    v_cvt_pk_bf16_f32 v32, v24, v25
    v_cvt_pk_bf16_f32 v33, v26, v27
    s_mov_b32 exec_lo, s59
    s_mov_b32 exec_hi, s59
    buffer_store_dwordx4 v[28:31], v108, s[8:11], s54 offen sc1
    s_mov_b64 exec, 0xffff
    buffer_store_dwordx2 v[32:33], v109, s[8:11], s55 offen offset:1280 sc1
    s_mov_b64 exec, -1
    s_setprio 0
    buffer_load_dword v15, v8, s[8:11], 0 offen sc1
    s_mul_i32 s39, s32, 6912
    s_add_u32 m0, s39, 58880
    s_add_u32 s46, s39, 0
    s_add_u32 s46, s46, s45
    buffer_load_dwordx4 v3, s[8:11], s46 offen offset:0 sc1 lds
    s_mov_b32 s47, 0
    s_atomic_add s47, s[8:9], s91 glc
    buffer_load_dwordx4 v3, s[8:11], s46 offen offset:1024 sc1 lds
    buffer_load_dwordx4 v3, s[8:11], s46 offen offset:2048 sc1 lds
    buffer_load_dwordx4 v3, s[8:11], s46 offen offset:3072 sc1 lds
    s_mul_i32 s39, s32, 6912
    s_add_u32 m0, s39, 62976
    s_add_u32 s46, s39, 4096
    s_add_u32 s46, s46, s45
    buffer_load_dwordx4 v3, s[8:11], s46 offen offset:0 sc1 lds
    buffer_load_dwordx4 v3, s[8:11], s46 offen offset:1024 sc1 lds
    s_mov_b32 exec_lo, 0xffffffff
    s_mov_b32 exec_hi, 0xffff
    buffer_load_dwordx4 v3, s[8:11], s46 offen offset:2048 sc1 lds
    s_mov_b64 exec, -1
    s_branch L_pg_pz
    .p2align 12
L_pg_pz:
    s_waitcnt vmcnt(7)
L_chk4:
    v_cmp_ne_u32 vcc, s36, v15
    s_cbranch_vccnz L_rep4
L_ok4:
    s_add_u32 m0, s17, 0
    s_nop 0
    buffer_load_dwordx4 v63, s[8:11], s16 offen sc1 lds
    s_add_u32 m0, s17, 1024
    s_nop 0
    buffer_load_dwordx4 v64, s[8:11], s16 offen sc1 lds
    s_add_u32 m0, s17, 2048
    s_nop 0
    buffer_load_dwordx4 v65, s[8:11], s16 offen sc1 lds
    s_add_u32 m0, s17, 3072
    s_nop 0
    buffer_load_dwordx4 v66, s[8:11], s16 offen sc1 lds
    s_add_u32 m0, s17, 4096
    s_mov_b32 exec_hi, 0
    buffer_load_dwordx4 v67, s[8:11], s16 offen sc1 lds
    s_mov_b64 exec, -1
    v_lshl_add_u32 v78, v2, 4, s5
    v_lshl_add_u32 v79, v2, 8, v109
    v_and_b32 v72, 7, v1
    v_lshlrev_b32 v72, 4, v72
    v_lshl_add_u32 v72, v2, 7, v72
    v_add_u32 v72, 44544, v72
    v_add_u32 v73, 64512, v68
    v_add_u32 v74, 64512, v69
    v_add_u32 v75, 64512, v70
    v_add_u32 v76, 64512, v71
    v_add_u32 v77, 64512, v72
    s_mov_b32 s49, 64
    s_mov_b32 s50, 64
    s_waitcnt lgkmcnt(0)
    s_sub_u32 s47, s47, s3
    s_cmp_eq_u32 s47, 16
    s_cbranch_scc0 L_rep5
L_ok5:
L_N_gather:
    buffer_load_dwordx4 v[112:115], v9, s[8:11], s12 offen offset:0 sc1
    v_mov_b32 v16, 0
    buffer_load_dwordx4 v[116:119], v9, s[8:11], s12 offen offset:256 sc1
    v_mov_b32 v17, 0
    buffer_load_dwordx4 v[120:123], v9, s[8:11], s12 offen offset:512 sc1
    v_mov_b32 v18, 0
    buffer_load_dwordx4 v[124:127], v9, s[8:11], s13 offen offset:0 sc1
    v_mov_b32 v19, 0
    buffer_load_dwordx4 v[128:131], v9, s[8:11], s13 offen offset:256 sc1
    v_mov_b32 v20, 0
    buffer_load_dwordx4 v[132:135], v9, s[8:11], s13 offen offset:512 sc1
    v_mov_b32 v21, 0
    buffer_load_dwordx4 v[136:139], v9, s[8:11], s14 offen offset:0 sc1
    v_mov_b32 v22, 0
    buffer_load_dwordx4 v[140:143], v9, s[8:11], s14 offen offset:256 sc1
    v_mov_b32 v23, 0
    buffer_load_dwordx4 v[144:147], v9, s[8:11], s14 offen offset:512 sc1
    v_mov_b32 v24, 0
    buffer_load_dwordx4 v[148:151], v9, s[8:11], s15 offen offset:0 sc1
    v_mov_b32 v25, 0
    buffer_load_dwordx4 v[152:155], v9, s[8:11], s15 offen offset:256 sc1
    v_mov_b32 v26, 0
    buffer_load_dwordx4 v[156:159], v9, s[8:11], s15 offen offset:512 sc1
    v_mov_b32 v27, 0
    s_mov_b32 s46, 0
    s_setprio 1
    s_waitcnt vmcnt(9)
    v_max3_u32 v28, v115, v119, v123
    v_cmp_eq_u32 vcc, -1, v28
    s_cbranch_vccnz L_gmissa0
    v_mfma_f32_16x16x32_bf16 v[16:19], v[56:59], v[112:115], v[16:19]
    v_mfma_f32_16x16x32_bf16 v[20:23], v[56:59], v[116:119], v[20:23]
    v_mfma_f32_16x16x32_bf16 v[24:27], v[56:59], v[120:123], v[24:27]
L_gnexta0:
    s_waitcnt vmcnt(6)
    v_max3_u32 v28, v127, v131, v135
    v_cmp_eq_u32 vcc, -1, v28
    s_cbranch_vccnz L_gmissa1
    v_mfma_f32_16x16x32_bf16 v[16:19], v[56:59], v[124:127], v[16:19]
    v_mfma_f32_16x16x32_bf16 v[20:23], v[56:59], v[128:131], v[20:23]
    v_mfma_f32_16x16x32_bf16 v[24:27], v[56:59], v[132:135], v[24:27]
L_gnexta1:
    s_waitcnt vmcnt(3)
    v_max3_u32 v28, v139, v143, v147
    v_cmp_eq_u32 vcc, -1, v28
    s_cbranch_vccnz L_gmissa2
    v_mfma_f32_16x16x32_bf16 v[16:19], v[56:59], v[136:139], v[16:19]
    v_mfma_f32_16x16x32_bf16 v[20:23], v[56:59], v[140:143], v[20:23]
    v_mfma_f32_16x16x32_bf16 v[24:27], v[56:59], v[144:147], v[24:27]
L_gnexta2:
    s_waitcnt vmcnt(0)
    v_max3_u32 v28, v151, v155, v159
    v_cmp_eq_u32 vcc, -1, v28
    s_cbranch_vccnz L_gmissa3
    v_mfma_f32_16x16x32_bf16 v[16:19], v[56:59], v[148:151], v[16:19]
    v_mfma_f32_16x16x32_bf16 v[20:23], v[56:59], v[152:155], v[20:23]
    v_mfma_f32_16x16x32_bf16 v[24:27], v[56:59], v[156:159], v[24:27]
L_gnexta3:
    s_cmp_lg_u32 s46, 0
    s_cbranch_scc1 L_gmore
L_gdone:
    s_mov_b32 exec_hi, 0
    s_nop 2
    v_cvt_pk_bf16_f32 v30, v16, v17
    v_cvt_pk_bf16_f32 v31, v18, v19
    ds_write_b64 v60, v[30:31]
    v_cvt_pk_bf16_f32 v32, v20, v21
    v_cvt_pk_bf16_f32 v33, v22, v23
    ds_write_b64 v61, v[32:33]
    v_cvt_pk_bf16_f32 v34, v24, v25
    v_cvt_pk_bf16_f32 v35, v26, v27
    ds_write_b64 v62, v[34:35]
    v_add_f32 v16, v16, v20
    v_cmp_u_f32 vcc, v16, v24
    s_mov_b64 exec, -1
    s_cbranch_vccnz L_N_regather
L_N_gathered:
    s_setprio 0
    s_waitcnt lgkmcnt(0)
    s_barrier
    s_lshl2_add_u32 s51, s33, s32
    s_lshl_b32 s51, s51, 7
    s_add_u32 s51, s51, 77824
    s_mul_i32 s39, s32, 4608
    s_add_u32 m0, s39, 123392
    s_add_u32 s46, s39, 64512
    s_add_u32 s46, s46, s45
    buffer_load_dwordx4 v3, s[8:11], s46 offen offset:0 sc1 lds
    buffer_load_dwordx4 v3, s[8:11], s46 offen offset:1024 sc1 lds
    s_mov_b32 s53, 1
    s_atomic_add s53, s[8:9], s51 glc
    buffer_load_dwordx4 v3, s[8:11], s46 offen offset:2048 sc1 lds
    buffer_load_dwordx4 v3, s[8:11], s46 offen offset:3072 sc1 lds
    s_mul_i32 s39, s32, 4608
    s_add_u32 m0, s39, 127488
    s_add_u32 s46, s39, 68608
    s_add_u32 s46, s46, s45
    s_mov_b32 exec_lo, 0xffffffff
    s_mov_b32 exec_hi, 0x0
    buffer_load_dwordx4 v3, s[8:11], s46 offen offset:0 sc1 lds
    s_mov_b64 exec, -1
    ds_read_b128 v[36:39], v78
    ds_read_b128 v[248:251], v68 offset:18432
    ds_read_b128 v[252:255], v69 offset:18432
    ds_read_b128 v[80:83], v70 offset:18432
    ds_read_b128 v[84:87], v71 offset:18432
    ds_read_b128 v[88:91], v72 offset:18432
    ds_read_b128 v[92:95], v68 offset:23040
    ds_read_b128 v[96:99], v69 offset:23040
    ds_read_b128 v[100:103], v70 offset:23040
    ds_read_b128 v[104:107], v71 offset:23040
    ds_read_b128 v[108:111], v72 offset:23040
    ds_read_b128 v[60:63], v68 offset:27648
    ds_read_b128 v[64:67], v69 offset:27648
    ds_read_b128 v[4:7], v70 offset:27648
    ds_read_b128 v[8:11], v71 offset:27648
    ds_read_b128 v[184:187], v72 offset:27648
    ds_read_b128 v[188:191], v68 offset:32256
    ds_read_b128 v[192:195], v69 offset:32256
    ds_read_b128 v[196:199], v70 offset:32256
    ds_read_b128 v[200:203], v71 offset:32256
    ds_read_b128 v[204:207], v72 offset:32256
    s_barrier
    ds_read_b128 v[112:115], v68 offset:0
    ds_read_b128 v[116:119], v69 offset:0
    ds_read_b128 v[120:123], v70 offset:0
    ds_read_b128 v[124:127], v71 offset:0
    ds_read_b128 v[128:131], v72 offset:0
    ds_read_b128 v[132:135], v68 offset:4608
    ds_read_b128 v[136:139], v69 offset:4608
    ds_read_b128 v[140:143], v70 offset:4608
    ds_read_b128 v[144:147], v71 offset:4608
    ds_read_b128 v[148:151], v72 offset:4608
    s_waitcnt lgkmcnt(5)
    v_mfma_f32_16x16x32_bf16 v[16:19], v[40:43], v[112:115], 0
    ds_read_b128 v[152:155], v68 offset:9216
    v_mfma_f32_16x16x32_bf16 v[20:23], v[40:43], v[116:119], 0
    ds_read_b128 v[156:159], v69 offset:9216
    v_mfma_f32_16x16x32_bf16 v[24:27], v[40:43], v[120:123], 0
    ds_read_b128 v[160:163], v70 offset:9216
    v_mfma_f32_16x16x32_bf16 v[28:31], v[40:43], v[124:127], 0
    ds_read_b128 v[164:167], v71 offset:9216
    v_mfma_f32_16x16x32_bf16 v[32:35], v[40:43], v[128:131], 0
    ds_read_b128 v[168:171], v72 offset:9216
    s_waitcnt lgkmcnt(5)
    v_mfma_f32_16x16x32_bf16 v[16:19], v[44:47], v[132:135], v[16:19]
    ds_read_b128 v[112:115], v68 offset:13824
    s_waitcnt lgkmcnt(0)
    s_sub_u32 s53, s53, s3
    s_cmp_lt_u32 s53, 0x80
    s_cbranch_scc0 L_rep6
L_ok6:
    s_mov_b32 s47, 0
    s_atomic_add s47, s[8:9], s6 glc
    v_mfma_f32_16x16x32_bf16 v[20:23], v[44:47], v[136:139], v[20:23]
    ds_read_b128 v[116:119], v69 offset:13824
    v_mfma_f32_16x16x32_bf16 v[24:27], v[44:47], v[140:143], v[24:27]
    ds_read_b128 v[120:123], v70 offset:13824
    v_mfma_f32_16x16x32_bf16 v[28:31], v[44:47], v[144:147], v[28:31]
    ds_read_b128 v[124:127], v71 offset:13824
    v_mfma_f32_16x16x32_bf16 v[32:35], v[44:47], v[148:151], v[32:35]
    ds_read_b128 v[128:131], v72 offset:13824
    ds_read_b32 v12, v3
    v_mfma_f32_16x16x32_bf16 v[16:19], v[48:51], v[152:155], v[16:19]
    v_mfma_f32_16x16x32_bf16 v[20:23], v[48:51], v[156:159], v[20:23]
    v_mfma_f32_16x16x32_bf16 v[24:27], v[48:51], v[160:163], v[24:27]
    v_mfma_f32_16x16x32_bf16 v[28:31], v[48:51], v[164:167], v[28:31]
    v_mfma_f32_16x16x32_bf16 v[32:35], v[48:51], v[168:171], v[32:35]
    s_waitcnt lgkmcnt(1)
    v_mfma_f32_16x16x32_bf16 v[16:19], v[52:55], v[112:115], v[16:19]
    v_mfma_f32_16x16x32_bf16 v[20:23], v[52:55], v[116:119], v[20:23]
    v_mfma_f32_16x16x32_bf16 v[24:27], v[52:55], v[120:123], v[24:27]
    v_mfma_f32_16x16x32_bf16 v[28:31], v[52:55], v[124:127], v[28:31]
    v_mfma_f32_16x16x32_bf16 v[32:35], v[52:55], v[128:131], v[32:35]
    s_nop 3
    v_mul_f32 v40, v16, v36
    v_mul_f32 v41, v17, v37
    v_mul_f32 v42, v18, v38
    v_mul_f32 v43, v19, v39
    v_mul_f32 v44, v20, v36
    v_mul_f32 v45, v21, v37
    v_mul_f32 v46, v22, v38
    v_mul_f32 v47, v23, v39
    v_mul_f32 v48, v24, v36
    v_mul_f32 v49, v25, v37
    v_mul_f32 v50, v26, v38
    v_mul_f32 v51, v27, v39
    v_mul_f32 v52, v28, v36
    v_mul_f32 v53, v29, v37
    v_mul_f32 v54, v30, v38
    v_mul_f32 v55, v31, v39
    v_mul_f32 v56, v32, v36
    v_mul_f32 v57, v33, v37
    v_mul_f32 v58, v34, v38
    v_mul_f32 v59, v35, v39
    s_waitcnt vmcnt(0)
    s_barrier
    ds_read_b128 v[208:211], v73 offset:27648
    ds_read_b128 v[212:215], v74 offset:27648
    ds_read_b128 v[216:219], v75 offset:27648
    ds_read_b128 v[220:223], v76 offset:27648
    ds_read_b128 v[224:227], v77 offset:27648
    ds_read_b128 v[228:231], v73 offset:32256
    ds_read_b128 v[232:235], v74 offset:32256
    ds_read_b128 v[236:239], v75 offset:32256
    ds_read_b128 v[240:243], v76 offset:32256
    ds_read_b128 v[244:247], v77 offset:32256
    s_waitcnt lgkmcnt(0)
    s_sub_u32 s47, s47, s3
    s_cmp_eq_u32 s47, 16
    s_cbranch_scc0 L_rep7
L_ok7:
    s_or_b32 s38, s2, s32
    s_cbranch_scc0 L_N_ep
L_N_out:
    buffer_load_dwordx2 v[176:177], v79, s[8:11], s22 offen offset:0 sc1
    buffer_load_dwordx2 v[178:179], v79, s[8:11], s22 offen offset:128 sc1
    buffer_load_dwordx2 v[180:181], v79, s[8:11], s22 offen offset:1024 sc1
    buffer_load_dwordx2 v[182:183], v79, s[8:11], s22 offen offset:1152 sc1
    buffer_load_dwordx4 v[112:115], v3, s[8:11], s18 offen offset:0 sc1
    buffer_load_dwordx4 v[116:119], v3, s[8:11], s18 offen offset:1024 sc1
    buffer_load_dwordx4 v[120:123], v3, s[8:11], s18 offen offset:2048 sc1
    buffer_load_dwordx4 v[124:127], v3, s[8:11], s18 offen offset:3072 sc1
    buffer_load_dwordx4 v[128:131], v3, s[8:11], s19 offen offset:0 sc1
    s_waitcnt vmcnt(5)
    v_max3_u32 v12, v177, v179, v181
    v_max_u32 v12, v12, v183
    v_cmp_eq_u32 vcc, -1, v12
    s_cbranch_vccnz L_omiss
L_ogo:
    v_mfma_f32_16x16x32_bf16 v[16:19], v[176:179], v[208:211], v[40:43]
    buffer_load_dwordx4 v[132:135], v3, s[8:11], s19 offen offset:1024 sc1
    v_mfma_f32_16x16x32_bf16 v[20:23], v[176:179], v[212:215], v[44:47]
    ds_read_b128 v[208:211], v68 offset:36864
    v_mfma_f32_16x16x32_bf16 v[24:27], v[176:179], v[216:219], v[48:51]
    ds_read_b128 v[212:215], v69 offset:36864
    v_mfma_f32_16x16x32_bf16 v[28:31], v[176:179], v[220:223], v[52:55]
    ds_read_b128 v[216:219], v70 offset:36864
    v_mfma_f32_16x16x32_bf16 v[32:35], v[176:179], v[224:227], v[56:59]
    v_mfma_f32_16x16x32_bf16 v[16:19], v[180:183], v[228:231], v[16:19]
    buffer_load_dwordx4 v[136:139], v3, s[8:11], s19 offen offset:2048 sc1
    v_mfma_f32_16x16x32_bf16 v[20:23], v[180:183], v[232:235], v[20:23]
    ds_read_b128 v[220:223], v71 offset:36864
    v_mfma_f32_16x16x32_bf16 v[24:27], v[180:183], v[236:239], v[24:27]
    ds_read_b128 v[224:227], v72 offset:36864
    v_mfma_f32_16x16x32_bf16 v[28:31], v[180:183], v[240:243], v[28:31]
    ds_read_b128 v[228:231], v68 offset:41472
    v_mfma_f32_16x16x32_bf16 v[32:35], v[180:183], v[244:247], v[32:35]
    s_waitcnt vmcnt(6)
    v_mfma_f32_16x16x32_bf16 v[16:19], v[112:115], v[248:251], v[16:19]
    buffer_load_dwordx4 v[140:143], v3, s[8:11], s19 offen offset:3072 sc1
    v_mfma_f32_16x16x32_bf16 v[20:23], v[112:115], v[252:255], v[20:23]
    ds_read_b128 v[232:235], v69 offset:41472
    v_mfma_f32_16x16x32_bf16 v[24:27], v[112:115], v[80:83], v[24:27]
    ds_read_b128 v[236:239], v70 offset:41472
    v_mfma_f32_16x16x32_bf16 v[28:31], v[112:115], v[84:87], v[28:31]
    ds_read_b128 v[240:243], v71 offset:41472
    v_mfma_f32_16x16x32_bf16 v[32:35], v[112:115], v[88:91], v[32:35]
    s_waitcnt vmcnt(6)
    v_mfma_f32_16x16x32_bf16 v[16:19], v[116:119], v[92:95], v[16:19]
    buffer_load_dwordx4 v[144:147], v3, s[8:11], s20 offen offset:0 sc1
    v_mfma_f32_16x16x32_bf16 v[20:23], v[116:119], v[96:99], v[20:23]
    ds_read_b128 v[244:247], v72 offset:41472
    v_mfma_f32_16x16x32_bf16 v[24:27], v[116:119], v[100:103], v[24:27]
    ds_read_b128 v[248:251], v68 offset:46080
    v_mfma_f32_16x16x32_bf16 v[28:31], v[116:119], v[104:107], v[28:31]
    ds_read_b128 v[252:255], v69 offset:46080
    v_mfma_f32_16x16x32_bf16 v[32:35], v[116:119], v[108:111], v[32:35]
    s_waitcnt vmcnt(6)
    v_mfma_f32_16x16x32_bf16 v[16:19], v[120:123], v[60:63], v[16:19]
    buffer_load_dwordx4 v[148:151], v3, s[8:11], s20 offen offset:1024 sc1
    v_mfma_f32_16x16x32_bf16 v[20:23], v[120:123], v[64:67], v[20:23]
    ds_read_b128 v[80:83], v70 offset:46080
    v_mfma_f32_16x16x32_bf16 v[24:27], v[120:123], v[4:7], v[24:27]
    ds_read_b128 v[84:87], v71 offset:46080
    v_mfma_f32_16x16x32_bf16 v[28:31], v[120:123], v[8:11], v[28:31]
    ds_read_b128 v[88:91], v72 offset:46080
    v_mfma_f32_16x16x32_bf16 v[32:35], v[120:123], v[184:187], v[32:35]
    s_waitcnt vmcnt(6)
    v_mfma_f32_16x16x32_bf16 v[16:19], v[124:127], v[188:191], v[16:19]
    buffer_load_dwordx4 v[152:155], v3, s[8:11], s20 offen offset:2048 sc1
    v_mfma_f32_16x16x32_bf16 v[20:23], v[124:127], v[192:195], v[20:23]
    ds_read_b128 v[92:95], v68 offset:50688
    v_mfma_f32_16x16x32_bf16 v[24:27], v[124:127], v[196:199], v[24:27]
    ds_read_b128 v[96:99], v69 offset:50688
    v_mfma_f32_16x16x32_bf16 v[28:31], v[124:127], v[200:203], v[28:31]
    ds_read_b128 v[100:103], v70 offset:50688
    v_mfma_f32_16x16x32_bf16 v[32:35], v[124:127], v[204:207], v[32:35]
    s_waitcnt vmcnt(6)
    s_waitcnt lgkmcnt(13)
    v_mfma_f32_16x16x32_bf16 v[16:19], v[128:131], v[208:211], v[16:19]
    buffer_load_dwordx4 v[156:159], v3, s[8:11], s20 offen offset:3072 sc1
    v_mfma_f32_16x16x32_bf16 v[20:23], v[128:131], v[212:215], v[20:23]
    ds_read_b128 v[104:107], v71 offset:50688
    v_mfma_f32_16x16x32_bf16 v[24:27], v[128:131], v[216:219], v[24:27]
    ds_read_b128 v[108:111], v72 offset:50688
    v_mfma_f32_16x16x32_bf16 v[28:31], v[128:131], v[220:223], v[28:31]
    ds_read_b128 v[60:63], v68 offset:55296
    v_mfma_f32_16x16x32_bf16 v[32:35], v[128:131], v[224:227], v[32:35]
    s_waitcnt vmcnt(6)
    s_waitcnt lgkmcnt(11)
    v_mfma_f32_16x16x32_bf16 v[16:19], v[132:135], v[228:231], v[16:19]
    buffer_load_dwordx4 v[160:163], v3, s[8:11], s21 offen offset:0 sc1
    v_mfma_f32_16x16x32_bf16 v[20:23], v[132:135], v[232:235], v[20:23]
    ds_read_b128 v[64:67], v69 offset:55296
    v_mfma_f32_16x16x32_bf16 v[24:27], v[132:135], v[236:239], v[24:27]
    ds_read_b128 v[4:7], v70 offset:55296
    v_mfma_f32_16x16x32_bf16 v[28:31], v[132:135], v[240:243], v[28:31]
    ds_read_b128 v[8:11], v71 offset:55296
    v_mfma_f32_16x16x32_bf16 v[32:35], v[132:135], v[244:247], v[32:35]
    ds_read_b128 v[184:187], v72 offset:55296
    s_waitcnt vmcnt(6)
    s_waitcnt lgkmcnt(10)
    v_mfma_f32_16x16x32_bf16 v[16:19], v[136:139], v[248:251], v[16:19]
    buffer_load_dwordx4 v[164:167], v3, s[8:11], s21 offen offset:1024 sc1
    v_mfma_f32_16x16x32_bf16 v[20:23], v[136:139], v[252:255], v[20:23]
    ds_read_b128 v[188:191], v68 offset:59904
    v_mfma_f32_16x16x32_bf16 v[24:27], v[136:139], v[80:83], v[24:27]
    ds_read_b128 v[192:195], v69 offset:59904
    v_mfma_f32_16x16x32_bf16 v[28:31], v[136:139], v[84:87], v[28:31]
    ds_read_b128 v[196:199], v70 offset:59904
    v_mfma_f32_16x16x32_bf16 v[32:35], v[136:139], v[88:91], v[32:35]
    ds_read_b128 v[200:203], v71 offset:59904
    s_waitcnt vmcnt(6)
    s_waitcnt lgkmcnt(9)
    v_mfma_f32_16x16x32_bf16 v[16:19], v[140:143], v[92:95], v[16:19]
    buffer_load_dwordx4 v[168:171], v3, s[8:11], s21 offen offset:2048 sc1
    v_mfma_f32_16x16x32_bf16 v[20:23], v[140:143], v[96:99], v[20:23]
    ds_read_b128 v[204:207], v72 offset:59904
    v_mfma_f32_16x16x32_bf16 v[24:27], v[140:143], v[100:103], v[24:27]
    ds_read_b128 v[208:211], v73 offset:0
    v_mfma_f32_16x16x32_bf16 v[28:31], v[140:143], v[104:107], v[28:31]
    ds_read_b128 v[212:215], v74 offset:0
    v_mfma_f32_16x16x32_bf16 v[32:35], v[140:143], v[108:111], v[32:35]
    ds_read_b128 v[216:219], v75 offset:0
    s_waitcnt vmcnt(6)
    s_waitcnt lgkmcnt(8)
    v_mfma_f32_16x16x32_bf16 v[16:19], v[144:147], v[60:63], v[16:19]
    buffer_load_dwordx4 v[172:175], v3, s[8:11], s21 offen offset:3072 sc1
    v_mfma_f32_16x16x32_bf16 v[20:23], v[144:147], v[64:67], v[20:23]
    ds_read_b128 v[220:223], v76 offset:0
    v_mfma_f32_16x16x32_bf16 v[24:27], v[144:147], v[4:7], v[24:27]
    ds_read_b128 v[224:227], v77 offset:0
    v_mfma_f32_16x16x32_bf16 v[28:31], v[144:147], v[8:11], v[28:31]
    ds_read_b128 v[228:231], v73 offset:4608
    v_mfma_f32_16x16x32_bf16 v[32:35], v[144:147], v[184:187], v[32:35]
    ds_read_b128 v[232:235], v74 offset:4608
    s_waitcnt vmcnt(6)
    s_waitcnt lgkmcnt(7)
    v_mfma_f32_16x16x32_bf16 v[16:19], v[148:151], v[188:191], v[16:19]
    ds_read_b128 v[236:239], v75 offset:4608
    v_mfma_f32_16x16x32_bf16 v[20:23], v[148:151], v[192:195], v[20:23]
    ds_read_b128 v[240:243], v76 offset:4608
    v_mfma_f32_16x16x32_bf16 v[24:27], v[148:151], v[196:199], v[24:27]
    ds_read_b128 v[244:247], v77 offset:4608
    v_mfma_f32_16x16x32_bf16 v[28:31], v[148:151], v[200:203], v[28:31]
    ds_read_b128 v[248:251], v73 offset:9216
    v_mfma_f32_16x16x32_bf16 v[32:35], v[148:151], v[204:207], v[32:35]
    ds_read_b128 v[252:255], v74 offset:9216
    s_waitcnt vmcnt(5)
    s_waitcnt lgkmcnt(7)
    v_mfma_f32_16x16x32_bf16 v[16:19], v[152:155], v[208:211], v[16:19]
    ds_read_b128 v[80:83], v75 offset:9216
    v_mfma_f32_16x16x32_bf16 v[20:23], v[152:155], v[212:215], v[20:23]
    ds_read_b128 v[84:87], v76 offset:9216
    v_mfma_f32_16x16x32_bf16 v[24:27], v[152:155], v[216:219], v[24:27]
    ds_read_b128 v[88:91], v77 offset:9216
    v_mfma_f32_16x16x32_bf16 v[28:31], v[152:155], v[220:223], v[28:31]
    ds_read_b128 v[92:95], v73 offset:13824
    v_mfma_f32_16x16x32_bf16 v[32:35], v[152:155], v[224:227], v[32:35]
    ds_read_b128 v[96:99], v74 offset:13824
    s_waitcnt vmcnt(4)
    s_waitcnt lgkmcnt(7)
    v_mfma_f32_16x16x32_bf16 v[16:19], v[156:159], v[228:231], v[16:19]
    ds_read_b128 v[100:103], v75 offset:13824
    v_mfma_f32_16x16x32_bf16 v[20:23], v[156:159], v[232:235], v[20:23]
    ds_read_b128 v[104:107], v76 offset:13824
    v_mfma_f32_16x16x32_bf16 v[24:27], v[156:159], v[236:239], v[24:27]
    ds_read_b128 v[108:111], v77 offset:13824
    v_mfma_f32_16x16x32_bf16 v[28:31], v[156:159], v[240:243], v[28:31]
    ds_read_b128 v[60:63], v73 offset:18432
    v_mfma_f32_16x16x32_bf16 v[32:35], v[156:159], v[244:247], v[32:35]
    ds_read_b128 v[64:67], v74 offset:18432
    s_waitcnt vmcnt(3)
    s_waitcnt lgkmcnt(7)
    v_mfma_f32_16x16x32_bf16 v[16:19], v[160:163], v[248:251], v[16:19]
    ds_read_b128 v[4:7], v75 offset:18432
    v_mfma_f32_16x16x32_bf16 v[20:23], v[160:163], v[252:255], v[20:23]
    ds_read_b128 v[8:11], v76 offset:18432
    v_mfma_f32_16x16x32_bf16 v[24:27], v[160:163], v[80:83], v[24:27]
    ds_read_b128 v[184:187], v77 offset:18432
    v_mfma_f32_16x16x32_bf16 v[28:31], v[160:163], v[84:87], v[28:31]
    ds_read_b128 v[188:191], v73 offset:23040
    v_mfma_f32_16x16x32_bf16 v[32:35], v[160:163], v[88:91], v[32:35]
    ds_read_b128 v[192:195], v74 offset:23040
    s_waitcnt vmcnt(2)
    s_waitcnt lgkmcnt(7)
    v_mfma_f32_16x16x32_bf16 v[16:19], v[164:167], v[92:95], v[16:19]
    ds_read_b128 v[196:199], v75 offset:23040
    v_mfma_f32_16x16x32_bf16 v[20:23], v[164:167], v[96:99], v[20:23]
    ds_read_b128 v[200:203], v76 offset:23040
    v_mfma_f32_16x16x32_bf16 v[24:27], v[164:167], v[100:103], v[24:27]
    ds_read_b128 v[204:207], v77 offset:23040
    v_mfma_f32_16x16x32_bf16 v[28:31], v[164:167], v[104:107], v[28:31]
    v_mfma_f32_16x16x32_bf16 v[32:35], v[164:167], v[108:111], v[32:35]
    s_waitcnt vmcnt(1)
    s_waitcnt lgkmcnt(5)
    v_mfma_f32_16x16x32_bf16 v[16:19], v[168:171], v[60:63], v[16:19]
    v_mfma_f32_16x16x32_bf16 v[20:23], v[168:171], v[64:67], v[20:23]
    v_mfma_f32_16x16x32_bf16 v[24:27], v[168:171], v[4:7], v[24:27]
    v_mfma_f32_16x16x32_bf16 v[28:31], v[168:171], v[8:11], v[28:31]
    v_mfma_f32_16x16x32_bf16 v[32:35], v[168:171], v[184:187], v[32:35]
    s_waitcnt vmcnt(0)
    s_waitcnt lgkmcnt(0)
    v_mfma_f32_16x16x32_bf16 v[16:19], v[172:175], v[188:191], v[16:19]
    v_mfma_f32_16x16x32_bf16 v[20:23], v[172:175], v[192:195], v[20:23]
    v_mfma_f32_16x16x32_bf16 v[24:27], v[172:175], v[196:199], v[24:27]
    v_mfma_f32_16x16x32_bf16 v[28:31], v[172:175], v[200:203], v[28:31]
    v_mfma_f32_16x16x32_bf16 v[32:35], v[172:175], v[204:207], v[32:35]
    s_or_b32 s38, s2, s32
    s_nop 2
    v_add_f32 v12, v16, v17
    v_add_f32 v15, v18, v19
    v_cmp_u_f32 vcc, v12, v15
    s_cbranch_vccnz L_N_redo
L_N_store:
    v_cvt_pk_bf16_f32 v112, v16, v20
    v_cvt_pk_bf16_f32 v113, v24, v28
    buffer_store_dwordx2 v[112:113], v13, s[28:31], s23 offen nt
    v_cvt_pk_bf16_f32 v114, v17, v21
    v_cvt_pk_bf16_f32 v115, v25, v29
    buffer_store_dwordx2 v[114:115], v13, s[28:31], s24 offen nt
    v_cvt_pk_bf16_f32 v116, v18, v22
    v_cvt_pk_bf16_f32 v117, v26, v30
    buffer_store_dwordx2 v[116:117], v13, s[28:31], s25 offen nt
    v_cvt_pk_bf16_f32 v118, v19, v23
    v_cvt_pk_bf16_f32 v119, v27, v31
    buffer_store_dwordx2 v[118:119], v13, s[28:31], s26 offen nt
    v_cvt_pk_bf16_f32 v120, v32, v33
    v_cvt_pk_bf16_f32 v121, v34, v35
    s_mov_b32 exec_lo, 0xff00ff
    s_mov_b32 exec_hi, 0xff00ff
    buffer_store_short v120, v14, s[28:31], s23 offen
    buffer_store_short_d16_hi v120, v14, s[28:31], s24 offen
    buffer_store_short v121, v14, s[28:31], s25 offen
    buffer_store_short_d16_hi v121, v14, s[28:31], s26 offen
L_N_noep:
    s_endpgm
L_rep4:
    s_sub_u32 s58, s58, 1
    s_cbranch_scc1 L_giveup4
    buffer_load_dword v15, v8, s[8:11], 0 offen sc1
    s_waitcnt vmcnt(0)
    s_branch L_chk4
L_giveup4:
    s_mov_b32 s58, 0
    s_branch L_ok4
L_rep5:
    s_cmp_lt_u32 s47, 0x80
    s_cselect_b32 s52, 0, 0
L_chk5:
    s_sub_u32 s58, s58, 1
    s_cbranch_scc1 L_giveup5
    s_mov_b32 s47, s52
    s_atomic_add s47, s[8:9], s91 glc
    s_waitcnt lgkmcnt(0)
    s_sub_u32 s47, s47, s3
    s_cmp_lt_u32 s47, 0x80
    s_cbranch_scc0 L_chk5
    s_add_u32 s47, s47, s52
    s_mov_b32 s52, 0
    s_cmp_ge_u32 s47, 16
    s_cbranch_scc0 L_chk5
    s_branch L_ok5
L_giveup5:
    s_mov_b32 s58, 0
    s_branch L_ok5
L_gmissa0:
    s_bitset1_b32 s46, 0
    buffer_load_dwordx4 v[112:115], v9, s[8:11], s12 offen offset:0 sc1
    buffer_load_dwordx4 v[116:119], v9, s[8:11], s12 offen offset:256 sc1
    buffer_load_dwordx4 v[120:123], v9, s[8:11], s12 offen offset:512 sc1
    s_branch L_gnexta0
L_gmissa1:
    s_bitset1_b32 s46, 1
    buffer_load_dwordx4 v[124:127], v9, s[8:11], s13 offen offset:0 sc1
    buffer_load_dwordx4 v[128:131], v9, s[8:11], s13 offen offset:256 sc1
    buffer_load_dwordx4 v[132:135], v9, s[8:11], s13 offen offset:512 sc1
    s_branch L_gnexta1
L_gmissa2:
    s_bitset1_b32 s46, 2
    buffer_load_dwordx4 v[136:139], v9, s[8:11], s14 offen offset:0 sc1
    buffer_load_dwordx4 v[140:143], v9, s[8:11], s14 offen offset:256 sc1
    buffer_load_dwordx4 v[144:147], v9, s[8:11], s14 offen offset:512 sc1
    s_branch L_gnexta2
L_gmissa3:
    s_bitset1_b32 s46, 3
    buffer_load_dwordx4 v[148:151], v9, s[8:11], s15 offen offset:0 sc1
    buffer_load_dwordx4 v[152:155], v9, s[8:11], s15 offen offset:256 sc1
    buffer_load_dwordx4 v[156:159], v9, s[8:11], s15 offen offset:512 sc1
    s_branch L_gnexta3
L_gmissb0:
    s_bitset1_b32 s46, 0
    buffer_load_dwordx4 v[112:115], v9, s[8:11], s12 offen offset:0 sc1
    buffer_load_dwordx4 v[116:119], v9, s[8:11], s12 offen offset:256 sc1
    buffer_load_dwordx4 v[120:123], v9, s[8:11], s12 offen offset:512 sc1
    s_branch L_gnextb0
L_gmissb1:
    s_bitset1_b32 s46, 1
    buffer_load_dwordx4 v[124:127], v9, s[8:11], s13 offen offset:0 sc1
    buffer_load_dwordx4 v[128:131], v9, s[8:11], s13 offen offset:256 sc1
    buffer_load_dwordx4 v[132:135], v9, s[8:11], s13 offen offset:512 sc1
    s_branch L_gnextb1
L_gmissb2:
    s_bitset1_b32 s46, 2
    buffer_load_dwordx4 v[136:139], v9, s[8:11], s14 offen offset:0 sc1
    buffer_load_dwordx4 v[140:143], v9, s[8:11], s14 offen offset:256 sc1
    buffer_load_dwordx4 v[144:147], v9, s[8:11], s14 offen offset:512 sc1
    s_branch L_gnextb2
L_gmissb3:
    s_bitset1_b32 s46, 3
    buffer_load_dwordx4 v[148:151], v9, s[8:11], s15 offen offset:0 sc1
    buffer_load_dwordx4 v[152:155], v9, s[8:11], s15 offen offset:256 sc1
    buffer_load_dwordx4 v[156:159], v9, s[8:11], s15 offen offset:512 sc1
    s_branch L_gnextb3
L_gmore:
    s_mov_b32 s47, s46
    s_mov_b32 s46, 0
    s_sub_u32 s58, s58, 1
    s_cbranch_scc1 L_ggive
    s_waitcnt vmcnt(0)
    s_bitcmp1_b32 s47, 0
    s_cbranch_scc0 L_gnextb0
    v_max3_u32 v28, v115, v119, v123
    v_cmp_eq_u32 vcc, -1, v28
    s_cbranch_vccnz L_gmissb0
    v_mfma_f32_16x16x32_bf16 v[16:19], v[56:59], v[112:115], v[16:19]
    v_mfma_f32_16x16x32_bf16 v[20:23], v[56:59], v[116:119], v[20:23]
    v_mfma_f32_16x16x32_bf16 v[24:27], v[56:59], v[120:123], v[24:27]
L_gnextb0:
    s_bitcmp1_b32 s47, 1
    s_cbranch_scc0 L_gnextb1
    v_max3_u32 v28, v127, v131, v135
    v_cmp_eq_u32 vcc, -1, v28
    s_cbranch_vccnz L_gmissb1
    v_mfma_f32_16x16x32_bf16 v[16:19], v[56:59], v[124:127], v[16:19]
    v_mfma_f32_16x16x32_bf16 v[20:23], v[56:59], v[128:131], v[20:23]
    v_mfma_f32_16x16x32_bf16 v[24:27], v[56:59], v[132:135], v[24:27]
L_gnextb1:
    s_bitcmp1_b32 s47, 2
    s_cbranch_scc0 L_gnextb2
    v_max3_u32 v28, v139, v143, v147
    v_cmp_eq_u32 vcc, -1, v28
    s_cbranch_vccnz L_gmissb2
    v_mfma_f32_16x16x32_bf16 v[16:19], v[56:59], v[136:139], v[16:19]
    v_mfma_f32_16x16x32_bf16 v[20:23], v[56:59], v[140:143], v[20:23]
    v_mfma_f32_16x16x32_bf16 v[24:27], v[56:59], v[144:147], v[24:27]
L_gnextb2:
    s_bitcmp1_b32 s47, 3
    s_cbranch_scc0 L_gnextb3
    v_max3_u32 v28, v151, v155, v159
    v_cmp_eq_u32 vcc, -1, v28
    s_cbranch_vccnz L_gmissb3
    v_mfma_f32_16x16x32_bf16 v[16:19], v[56:59], v[148:151], v[16:19]
    v_mfma_f32_16x16x32_bf16 v[20:23], v[56:59], v[152:155], v[20:23]
    v_mfma_f32_16x16x32_bf16 v[24:27], v[56:59], v[156:159], v[24:27]
L_gnextb3:
    s_cmp_lg_u32 s46, 0
    s_cbranch_scc1 L_gmore
    s_branch L_gdone
L_ggive:
    s_mov_b32 s58, 0
    s_branch L_gdone
L_N_regather:
    s_sub_u32 s49, s49, 1
    s_cbranch_scc0 L_N_gather
    s_branch L_N_gathered
L_rep6:
    s_cmp_lt_u32 s53, 0x80
    s_cselect_b32 s52, 0, 1
L_chk6:
    s_sub_u32 s58, s58, 1
    s_cbranch_scc1 L_giveup6
    s_mov_b32 s53, s52
    s_atomic_add s53, s[8:9], s51 glc
    s_waitcnt lgkmcnt(0)
    s_sub_u32 s53, s53, s3
    s_cmp_lt_u32 s53, 0x80
    s_cbranch_scc0 L_chk6
    s_add_u32 s53, s53, s52
    s_mov_b32 s52, 0
    s_cmp_ge_u32 s53, 0
    s_cbranch_scc0 L_chk6
    s_branch L_ok6
L_giveup6:
    s_mov_b32 s58, 0
    s_branch L_ok6
L_rep7:
    s_cmp_lt_u32 s47, 0x80
    s_cselect_b32 s52, 0, 0
L_chk7:
    s_sub_u32 s58, s58, 1
    s_cbranch_scc1 L_giveup7
    s_mov_b32 s47, s52
    s_atomic_add s47, s[8:9], s6 glc
    s_waitcnt lgkmcnt(0)
    s_sub_u32 s47, s47, s3
    s_cmp_lt_u32 s47, 0x80
    s_cbranch_scc0 L_chk7
    s_add_u32 s47, s47, s52
    s_mov_b32 s52, 0
    s_cmp_ge_u32 s47, 16
    s_cbranch_scc0 L_chk7
    s_branch L_ok7
L_giveup7:
    s_mov_b32 s58, 0
    s_branch L_ok7
L_N_ep:
    s_mov_b32 s54, s36
    s_atomic_swap s54, s[8:9], 0 glc
    s_branch L_N_out
L_omiss:
    s_sub_u32 s58, s58, 1
    s_cbranch_scc0 L_N_out
    s_mov_b32 s58, 0
    s_branch L_ogo
L_N_redo:
    s_sub_u32 s58, s58, 0
    s_sub_u32 s50, s50, 1
    s_cbranch_scc1 L_N_give
    ds_read_b128 v[208:211], v73 offset:27648
    ds_read_b128 v[212:215], v74 offset:27648
    ds_read_b128 v[216:219], v75 offset:27648
    ds_read_b128 v[220:223], v76 offset:27648
    ds_read_b128 v[224:227], v77 offset:27648
    ds_read_b128 v[228:231], v73 offset:32256
    ds_read_b128 v[232:235], v74 offset:32256
    ds_read_b128 v[236:239], v75 offset:32256
    ds_read_b128 v[240:243], v76 offset:32256
    ds_read_b128 v[244:247], v77 offset:32256
    ds_read_b128 v[248:251], v68 offset:18432
    ds_read_b128 v[252:255], v69 offset:18432
    ds_read_b128 v[80:83], v70 offset:18432
    ds_read_b128 v[84:87], v71 offset:18432
    ds_read_b128 v[88:91], v72 offset:18432
    ds_read_b128 v[92:95], v68 offset:23040
    ds_read_b128 v[96:99], v69 offset:23040
    ds_read_b128 v[100:103], v70 offset:23040
    ds_read_b128 v[104:107], v71 offset:23040
    ds_read_b128 v[108:111], v72 offset:23040
    ds_read_b128 v[60:63], v68 offset:27648
    ds_read_b128 v[64:67], v69 offset:27648
    ds_read_b128 v[4:7], v70 offset:27648
    ds_read_b128 v[8:11], v71 offset:27648
    ds_read_b128 v[184:187], v72 offset:27648
    ds_read_b128 v[188:191], v68 offset:32256
    ds_read_b128 v[192:195], v69 offset:32256
    ds_read_b128 v[196:199], v70 offset:32256
    ds_read_b128 v[200:203], v71 offset:32256
    ds_read_b128 v[204:207], v72 offset:32256
    s_waitcnt lgkmcnt(0)
    s_branch L_N_out
L_N_give:
    s_or_b32 s38, s2, s32
    s_branch L_N_store
L_end:
    s_endpgm
.section .rodata,"a"
.p2align 6
.amdhsa_kernel gated_mix__spectral_fnet__linear_kernel_hedgehog__prompt_kernel
  .amdhsa_next_free_vgpr 256
  .amdhsa_next_free_sgpr 102
  .amdhsa_accum_offset 256
  .amdhsa_group_segment_fixed_size 0
  .amdhsa_kernarg_size 104
  .amdhsa_user_sgpr_count 2
  .amdhsa_user_sgpr_kernarg_segment_ptr 1
  .amdhsa_system_sgpr_workgroup_id_x 1
.end_amdhsa_kernel
```
